```python
import torch

def _softmax(x, axis=-1):
    return torch.softmax(x, dim=axis)
def _gelu(x):
    return torch.nn.functional.gelu(x, approximate="tanh")
def _silu(x):
    return torch.nn.functional.silu(x)
def _sigmoid(x):
    return torch.sigmoid(x)
def _layernorm(x, axis=-1, eps=1e-5):
    m = x.mean(dim=axis, keepdim=True)
    v = x.var(dim=axis, keepdim=True, unbiased=False)
    return (x - m) / torch.sqrt(v + eps)
def _scatter_add(tgt, idx, src, axis=0):
    return tgt.clone().index_add_(axis, idx, src)
def _segment_sum(src, seg, n):
    out = torch.zeros((n,) + src.shape[1:], dtype=src.dtype)
    return out.index_add_(0, seg, src)
def _pad(x, pw):
    flat = tuple(v for pair in reversed(pw) for v in pair)
    return torch.nn.functional.pad(x, flat)

kernel_name = 'concat_heads__softmax_full_mha__sliding_local_dilated__prompt'

def setup_inputs():

    _w = (lambda a: (lambda t: t.to(torch.bfloat16) if t.is_floating_point() else t)(torch.as_tensor(a)))
    def _A_setup():
        B, S, D = 1, 2048, 640
        return {
            "x": _w((lambda *s: torch.randn(*s, dtype=torch.bfloat16) * 0.2)(B, S, D)),
            "wqkv": _w((lambda *s: torch.randn(*s, dtype=torch.bfloat16) * 0.4)(D, 3 * D)),
            "wo": _w((lambda *s: torch.randn(*s, dtype=torch.bfloat16) * 0.1)(D, D)),
        }
    _A_in = _A_setup()

    def _B_setup():
        B, S, D = 1, 2048, 640
        return {
            "x": _w((lambda *s: torch.randn(*s, dtype=torch.bfloat16) * 0.4)(B, S, D)),
            "wqkv": _w((lambda *s: torch.randn(*s, dtype=torch.bfloat16) * 0.4)(D, 3 * D)),
            "wo": _w((lambda *s: torch.randn(*s, dtype=torch.bfloat16) * 0.05)(D, D)),
        }
    _B_in = _B_setup()

    return {
        "A_x": _A_in["x"],
        "A_wqkv": _A_in["wqkv"],
        "A_wo": _A_in["wo"],
        "B_x": _B_in["x"],
        "B_wqkv": _B_in["wqkv"],
        "B_wo": _B_in["wo"],
    }

def reference(A_x, A_wqkv, A_wo, B_x, B_wqkv, B_wo):
    def _A_ref(x, wqkv, wo):
        B, S, D = x.shape
        H = 32; Dh = D // H
        qkv = (lambda x, *d: x.permute(*d))((x @ wqkv).reshape(B, S, 3, H, Dh), 2, 0, 3, 1, 4)
        q, k, v = qkv[0], qkv[1], qkv[2]
        scale = Dh ** -0.5
        scores = torch.einsum("bhqd,bhkd->bhqk", q, k) * scale
        p = _softmax(scores, axis=-1)
        o = torch.einsum("bhqk,bhkd->bhqd", p, v)
        return (lambda x, *d: x.permute(*d))(o, 0, 2, 1, 3).reshape(B, S, D) @ wo

    def _B_ref(x, wqkv, wo):
        B, S, D = x.shape
        H = 32; Dh = D // H
        W, dil = 8, 2
        qkv = (lambda x, *d: x.permute(*d))((x @ wqkv).reshape(B, S, 3, H, Dh), 2, 0, 3, 1, 4)
        q, k, v = qkv[0], qkv[1], qkv[2]
        scale = Dh ** -0.5
        pos = torch.arange(S)
        off = torch.arange(W) * dil
        idx = pos[:, None] - off[None, :]
        mask = idx >= 0
        idx_c = torch.where(mask, idx, 0).reshape(-1)
        kg = k[:, :, idx_c, :].reshape(B, H, S, W, Dh)
        vg = v[:, :, idx_c, :].reshape(B, H, S, W, Dh)
        logits = torch.einsum("bhsd,bhswd->bhsw", q, kg) * scale
        logits = torch.where(mask[None, None, :, :], logits, -1e9)
        attn = _softmax(logits, axis=-1)
        o = torch.einsum("bhsw,bhswd->bhsd", attn, vg)
        return (lambda x, *d: x.permute(*d))(o, 0, 2, 1, 3).reshape(B, S, D) @ wo

    a = _A_ref(A_x, A_wqkv, A_wo)
    b = _B_ref(B_x, B_wqkv, B_wo)
    return torch.concatenate([a, b], axis=-1)
```

```asm
; @launch kernel=qkv_kernel grid=(256,1,1) block=(512,1,1) lds=147456
; @launch kernel=tail_kernel grid=(256,1,1) block=(512,1,1) lds=160832
.amdgcn_target "amdgcn-amd-amdhsa--gfx950"
.text
.globl qkv_kernel
.p2align 8
.type qkv_kernel,@function
qkv_kernel:
  s_cmp_ge_u32 s2, 256
  s_cbranch_scc1 L_qkv_kernel_exit
  s_load_dwordx4 s[4:7], s[0:1], 0
  s_load_dwordx4 s[32:35], s[0:1], 24
  s_load_dwordx2 s[36:37], s[0:1], 64
  s_and_b32 s30, s2, 7
  s_lshr_b32 s31, s2, 3
  s_lshr_b32 s20, s30, 2
  s_and_b32 s21, s30, 1
  s_lshl_b32 s21, s21, 2
  s_and_b32 s3, s31, 3
  s_add_u32 s21, s21, s3
  s_lshr_b32 s22, s30, 1
  s_and_b32 s22, s22, 1
  s_lshl_b32 s22, s22, 3
  s_lshr_b32 s3, s31, 2
  s_add_u32 s22, s22, s3
  s_mul_i32 s23, s22, 52
  s_lshr_b32 s23, s23, 8
  s_mul_i32 s3, s23, 5
  s_sub_u32 s24, s22, s3
  v_and_b32 v1, 63, v0
  v_lshrrev_b32 v4, 6, v0
  v_and_b32 v2, 31, v1
  v_readfirstlane_b32 s25, v4
  v_lshrrev_b32 v3, 5, v1
  s_waitcnt lgkmcnt(0)
  s_cmp_eq_u32 s20, 0
  s_cselect_b32 s4, s4, s32
  s_cselect_b32 s5, s5, s33
  s_cselect_b32 s6, s6, s34
  s_cselect_b32 s7, s7, s35
  s_mov_b32 s8, s4
  s_and_b32 s9, s5, 0xffff
  s_mov_b32 s10, 2621440
  s_mov_b32 s11, 0x20000
  s_mov_b32 s12, s6
  s_and_b32 s13, s7, 0xffff
  s_mov_b32 s14, 2457600
  s_mov_b32 s15, 0x20000
  s_mov_b32 s16, s36
  s_and_b32 s17, s37, 0xffff
  s_mov_b32 s18, 20971520
  s_mov_b32 s19, 0x20000
  s_cmp_ge_u32 s22, 15
  s_cbranch_scc0 L_qkv_kernel_act
  s_load_dwordx2 s[40:41], s[0:1], 16
  s_load_dwordx2 s[42:43], s[0:1], 40
  s_lshr_b32 s3, s2, 3
  s_and_b32 s3, s3, 3
  s_bfe_u32 s30, s2, 0x10000
  s_lshl_b32 s30, s30, 2
  s_add_u32 s3, s3, s30
  s_lshl_b32 s3, s3, 3
  s_add_u32 s3, s3, s25
  s_mul_i32 s3, s3, 12800
  v_lshlrev_b32 v4, 6, v1
  s_waitcnt lgkmcnt(0)
  s_cmp_eq_u32 s20, 0
  s_cselect_b32 s40, s40, s42
  s_cselect_b32 s41, s41, s43
  s_mov_b32 s44, s40
  s_and_b32 s45, s41, 0xffff
  s_mov_b32 s46, 819200
  s_mov_b32 s47, 0x20000
  buffer_load_dword v30, v4, s[44:47], s3 offen
  s_add_u32 s3, s3, 4096
  buffer_load_dword v31, v4, s[44:47], s3 offen
  s_add_u32 s3, s3, 4096
  buffer_load_dword v32, v4, s[44:47], s3 offen
  s_add_u32 s3, s3, 4096
  buffer_load_dword v33, v4, s[44:47], s3 offen
  s_add_u32 s3, s3, 4096
  s_waitcnt vmcnt(0)
  s_branch L_qkv_kernel_exit
L_qkv_kernel_act:
  v_lshrrev_b32 v4, 4, v1
  s_and_b32 s3, s25, 1
  s_lshl_b32 s3, s3, 2
  v_add_u32 v4, s3, v4
  v_and_b32 v5, 7, v1
  v_xor_b32 v4, v4, v5
  v_lshlrev_b32 v4, 4, v4
  v_lshrrev_b32 v5, 3, v1
  s_lshl_b32 s3, s25, 3
  v_add_u32 v5, s3, v5
  v_mul_u32_u24 v5, 1280, v5
  v_add_u32 v8, v4, v5
  s_mul_i32 s26, s21, 327680
  v_lshrrev_b32 v4, 4, v1
  v_bfe_u32 v5, v1, 2, 2
  v_xor_b32 v5, v5, v4
  v_lshlrev_b32 v5, 2, v5
  v_and_b32 v6, 3, v1
  v_or_b32 v5, v5, v6
  v_lshlrev_b32 v5, 4, v5
  s_lshl_b32 s3, s25, 2
  v_add_u32 v4, s3, v4
  v_mul_u32_u24 v4, 3840, v4
  v_add_u32 v9, v4, v5
  s_lshl_b32 s27, s22, 8
  s_lshl_b32 s28, s25, 10
  s_add_u32 s29, s28, 32768
  s_add_u32 m0, s28, 0
  s_add_u32 s30, s26, 0
  buffer_load_dwordx4 v8, s[8:11], s30 offen lds
  s_add_u32 m0, s28, 8192
  s_add_u32 s30, s26, 81920
  buffer_load_dwordx4 v8, s[8:11], s30 offen lds
  s_add_u32 m0, s28, 16384
  s_add_u32 s30, s26, 163840
  buffer_load_dwordx4 v8, s[8:11], s30 offen lds
  s_add_u32 m0, s28, 24576
  s_add_u32 s30, s26, 245760
  buffer_load_dwordx4 v8, s[8:11], s30 offen lds
  s_add_u32 m0, s29, 0
  s_add_u32 s30, s27, 0
  buffer_load_dwordx4 v9, s[12:15], s30 offen lds
  s_add_u32 m0, s29, 8192
  s_add_u32 s30, s27, 122880
  buffer_load_dwordx4 v9, s[12:15], s30 offen lds
  s_add_u32 m0, s28, 49152
  s_add_u32 s30, s26, 128
  buffer_load_dwordx4 v8, s[8:11], s30 offen lds
  s_add_u32 m0, s28, 57344
  s_add_u32 s30, s26, 82048
  buffer_load_dwordx4 v8, s[8:11], s30 offen lds
  s_add_u32 m0, s28, 65536
  s_add_u32 s30, s26, 163968
  buffer_load_dwordx4 v8, s[8:11], s30 offen lds
  s_add_u32 m0, s28, 73728
  s_add_u32 s30, s26, 245888
  buffer_load_dwordx4 v8, s[8:11], s30 offen lds
  s_add_u32 m0, s29, 49152
  s_add_u32 s30, s27, 245760
  buffer_load_dwordx4 v9, s[12:15], s30 offen lds
  s_add_u32 m0, s29, 57344
  s_add_u32 s30, s27, 368640
  buffer_load_dwordx4 v9, s[12:15], s30 offen lds
  s_cmp_eq_u32 s20, 0
  s_cbranch_scc0 L_qkv_kernel_tokB
  s_cmp_eq_u32 s23, 0
  s_cbranch_scc0 L_qkv_kernel_tokPi
  v_mov_b32 v6, v2
  s_branch L_qkv_kernel_tokD
L_qkv_kernel_tokPi:
  v_and_b32 v6, 0x13, v2
  v_and_b32 v4, 4, v2
  v_lshl_or_b32 v6, v4, 1, v6
  v_and_b32 v4, 8, v2
  v_lshrrev_b32 v4, 1, v4
  v_or_b32 v6, v6, v4
  s_branch L_qkv_kernel_tokD
L_qkv_kernel_tokB:
  s_cmp_eq_u32 s23, 2
  s_cbranch_scc1 L_qkv_kernel_tokBV
  v_and_b32 v6, 15, v2
  v_lshlrev_b32 v6, 1, v6
  v_lshrrev_b32 v4, 4, v2
  v_or_b32 v6, v6, v4
  s_branch L_qkv_kernel_tokD
L_qkv_kernel_tokBV:
  v_and_b32 v6, 3, v2
  v_bfe_u32 v4, v2, 3, 1
  v_lshl_or_b32 v6, v4, 2, v6
  v_lshlrev_b32 v6, 1, v6
  v_bfe_u32 v4, v2, 2, 1
  v_or_b32 v6, v6, v4
  v_and_b32 v4, 16, v2
  v_or_b32 v6, v6, v4
L_qkv_kernel_tokD:
  s_and_b32 s3, s25, 3
  s_lshl_b32 s3, s3, 6
  v_add_u32 v6, s3, v6
  v_bfe_u32 v4, v6, 1, 3
  v_xor_b32 v4, v4, v3
  v_lshlrev_b32 v6, 7, v6
  v_xor_b32 v5, 0, v4
  v_lshl_add_u32 v10, v5, 4, v6
  v_add_u32 v14, 49152, v10
  v_add_u32 v18, 98304, v10
  v_xor_b32 v5, 2, v4
  v_lshl_add_u32 v11, v5, 4, v6
  v_add_u32 v15, 49152, v11
  v_add_u32 v19, 98304, v11
  v_xor_b32 v5, 4, v4
  v_lshl_add_u32 v12, v5, 4, v6
  v_add_u32 v16, 49152, v12
  v_add_u32 v20, 98304, v12
  v_xor_b32 v5, 6, v4
  v_lshl_add_u32 v13, v5, 4, v6
  v_add_u32 v17, 49152, v13
  v_add_u32 v21, 98304, v13
  v_bfe_u32 v4, v1, 4, 1
  v_and_b32 v5, 3, v1
  v_lshl_or_b32 v4, v4, 2, v5
  v_lshlrev_b32 v4, 2, v4
  s_cmp_eq_u32 s23, 2
  s_cbranch_scc1 L_qkv_kernel_phiN
  v_and_b32 v5, 0x13, v4
  v_and_b32 v6, 4, v4
  v_lshl_or_b32 v5, v6, 1, v5
  v_and_b32 v6, 8, v4
  v_lshrrev_b32 v6, 1, v6
  v_or_b32 v5, v5, v6
  v_mov_b32 v4, v5
L_qkv_kernel_phiN:
  v_lshlrev_b32 v4, 1, v4
  v_bfe_u32 v5, v1, 2, 2
  v_lshlrev_b32 v6, 3, v3
  v_add_u32 v6, v6, v5
  v_lshl_add_u32 v4, v6, 8, v4
  s_lshr_b32 s3, s25, 2
  s_lshl_b32 s3, s3, 1
  s_add_u32 s30, s3, 0
  v_xor_b32 v6, s30, v5
  v_lshl_add_u32 v22, v6, 6, v4
  v_add_u32 v22, 32768, v22
  v_add_u32 v24, 49152, v22
  v_add_u32 v26, 98304, v22
  s_add_u32 s30, s3, 1
  v_xor_b32 v6, s30, v5
  v_lshl_add_u32 v23, v6, 6, v4
  v_add_u32 v23, 32768, v23
  v_add_u32 v25, 49152, v23
  v_add_u32 v27, 98304, v23
  v_mov_b32 v64, 0
  v_mov_b32 v65, 0
  v_mov_b32 v66, 0
  v_mov_b32 v67, 0
  v_mov_b32 v68, 0
  v_mov_b32 v69, 0
  v_mov_b32 v70, 0
  v_mov_b32 v71, 0
  v_mov_b32 v72, 0
  v_mov_b32 v73, 0
  v_mov_b32 v74, 0
  v_mov_b32 v75, 0
  v_mov_b32 v76, 0
  v_mov_b32 v77, 0
  v_mov_b32 v78, 0
  v_mov_b32 v79, 0
  v_mov_b32 v80, 0
  v_mov_b32 v81, 0
  v_mov_b32 v82, 0
  v_mov_b32 v83, 0
  v_mov_b32 v84, 0
  v_mov_b32 v85, 0
  v_mov_b32 v86, 0
  v_mov_b32 v87, 0
  v_mov_b32 v88, 0
  v_mov_b32 v89, 0
  v_mov_b32 v90, 0
  v_mov_b32 v91, 0
  v_mov_b32 v92, 0
  v_mov_b32 v93, 0
  v_mov_b32 v94, 0
  v_mov_b32 v95, 0
  v_mov_b32 v96, 0
  v_mov_b32 v97, 0
  v_mov_b32 v98, 0
  v_mov_b32 v99, 0
  v_mov_b32 v100, 0
  v_mov_b32 v101, 0
  v_mov_b32 v102, 0
  v_mov_b32 v103, 0
  v_mov_b32 v104, 0
  v_mov_b32 v105, 0
  v_mov_b32 v106, 0
  v_mov_b32 v107, 0
  v_mov_b32 v108, 0
  v_mov_b32 v109, 0
  v_mov_b32 v110, 0
  v_mov_b32 v111, 0
  v_mov_b32 v112, 0
  v_mov_b32 v113, 0
  v_mov_b32 v114, 0
  v_mov_b32 v115, 0
  v_mov_b32 v116, 0
  v_mov_b32 v117, 0
  v_mov_b32 v118, 0
  v_mov_b32 v119, 0
  v_mov_b32 v120, 0
  v_mov_b32 v121, 0
  v_mov_b32 v122, 0
  v_mov_b32 v123, 0
  v_mov_b32 v124, 0
  v_mov_b32 v125, 0
  v_mov_b32 v126, 0
  v_mov_b32 v127, 0
  s_cmp_eq_u32 s23, 2
  s_cbranch_scc1 L_qkv_kernel_vform
  s_waitcnt vmcnt(6) lgkmcnt(0)
  s_barrier
  ds_read_b128 v[32:35], v10 offset:0
  ds_read_b128 v[36:39], v10 offset:4096
  ds_read_b64_tr_b16 v[40:41], v22 offset:0
  ds_read_b64_tr_b16 v[42:43], v22 offset:1024
  ds_read_b64_tr_b16 v[44:45], v23 offset:0
  ds_read_b64_tr_b16 v[46:47], v23 offset:1024
  s_add_u32 m0, s28, 98304
  s_add_u32 s30, s26, 256
  buffer_load_dwordx4 v8, s[8:11], s30 offen lds
  s_add_u32 m0, s28, 106496
  s_add_u32 s30, s26, 82176
  buffer_load_dwordx4 v8, s[8:11], s30 offen lds
  s_waitcnt lgkmcnt(0)
  ds_read_b128 v[48:51], v11 offset:0
  ds_read_b128 v[52:55], v11 offset:4096
  ds_read_b64_tr_b16 v[56:57], v22 offset:4096
  ds_read_b64_tr_b16 v[58:59], v22 offset:5120
  ds_read_b64_tr_b16 v[60:61], v23 offset:4096
  ds_read_b64_tr_b16 v[62:63], v23 offset:5120
  v_mfma_f32_32x32x16_bf16 v[64:79], v[40:43], v[32:35], v[64:79]
  s_add_u32 m0, s28, 114688
  s_add_u32 s30, s26, 164096
  buffer_load_dwordx4 v8, s[8:11], s30 offen lds
  v_mfma_f32_32x32x16_bf16 v[80:95], v[40:43], v[36:39], v[80:95]
  v_mfma_f32_32x32x16_bf16 v[96:111], v[44:47], v[32:35], v[96:111]
  s_add_u32 m0, s28, 122880
  s_add_u32 s30, s26, 246016
  buffer_load_dwordx4 v8, s[8:11], s30 offen lds
  v_mfma_f32_32x32x16_bf16 v[112:127], v[44:47], v[36:39], v[112:127]
  s_waitcnt lgkmcnt(0)
  ds_read_b128 v[32:35], v12 offset:0
  ds_read_b128 v[36:39], v12 offset:4096
  ds_read_b64_tr_b16 v[40:41], v22 offset:8192
  ds_read_b64_tr_b16 v[42:43], v22 offset:9216
  ds_read_b64_tr_b16 v[44:45], v23 offset:8192
  ds_read_b64_tr_b16 v[46:47], v23 offset:9216
  v_mfma_f32_32x32x16_bf16 v[64:79], v[56:59], v[48:51], v[64:79]
  s_add_u32 m0, s29, 98304
  s_add_u32 s30, s27, 491520
  buffer_load_dwordx4 v9, s[12:15], s30 offen lds
  v_mfma_f32_32x32x16_bf16 v[80:95], v[56:59], v[52:55], v[80:95]
  v_mfma_f32_32x32x16_bf16 v[96:111], v[60:63], v[48:51], v[96:111]
  s_add_u32 m0, s29, 106496
  s_add_u32 s30, s27, 614400
  buffer_load_dwordx4 v9, s[12:15], s30 offen lds
  v_mfma_f32_32x32x16_bf16 v[112:127], v[60:63], v[52:55], v[112:127]
  s_waitcnt lgkmcnt(0)
  ds_read_b128 v[48:51], v13 offset:0
  ds_read_b128 v[52:55], v13 offset:4096
  ds_read_b64_tr_b16 v[56:57], v22 offset:12288
  ds_read_b64_tr_b16 v[58:59], v22 offset:13312
  ds_read_b64_tr_b16 v[60:61], v23 offset:12288
  ds_read_b64_tr_b16 v[62:63], v23 offset:13312
  v_mfma_f32_32x32x16_bf16 v[64:79], v[40:43], v[32:35], v[64:79]
  v_mfma_f32_32x32x16_bf16 v[80:95], v[40:43], v[36:39], v[80:95]
  v_mfma_f32_32x32x16_bf16 v[96:111], v[44:47], v[32:35], v[96:111]
  v_mfma_f32_32x32x16_bf16 v[112:127], v[44:47], v[36:39], v[112:127]
  s_waitcnt vmcnt(6) lgkmcnt(0)
  s_barrier
  ds_read_b128 v[32:35], v14 offset:0
  ds_read_b128 v[36:39], v14 offset:4096
  ds_read_b64_tr_b16 v[40:41], v24 offset:0
  ds_read_b64_tr_b16 v[42:43], v24 offset:1024
  ds_read_b64_tr_b16 v[44:45], v25 offset:0
  ds_read_b64_tr_b16 v[46:47], v25 offset:1024
  v_mfma_f32_32x32x16_bf16 v[64:79], v[56:59], v[48:51], v[64:79]
  s_add_u32 m0, s28, 0
  s_add_u32 s30, s26, 384
  buffer_load_dwordx4 v8, s[8:11], s30 offen lds
  v_mfma_f32_32x32x16_bf16 v[80:95], v[56:59], v[52:55], v[80:95]
  v_mfma_f32_32x32x16_bf16 v[96:111], v[60:63], v[48:51], v[96:111]
  s_add_u32 m0, s28, 8192
  s_add_u32 s30, s26, 82304
  buffer_load_dwordx4 v8, s[8:11], s30 offen lds
  v_mfma_f32_32x32x16_bf16 v[112:127], v[60:63], v[52:55], v[112:127]
  s_waitcnt lgkmcnt(0)
  ds_read_b128 v[48:51], v15 offset:0
  ds_read_b128 v[52:55], v15 offset:4096
  ds_read_b64_tr_b16 v[56:57], v24 offset:4096
  ds_read_b64_tr_b16 v[58:59], v24 offset:5120
  ds_read_b64_tr_b16 v[60:61], v25 offset:4096
  ds_read_b64_tr_b16 v[62:63], v25 offset:5120
  v_mfma_f32_32x32x16_bf16 v[64:79], v[40:43], v[32:35], v[64:79]
  s_add_u32 m0, s28, 16384
  s_add_u32 s30, s26, 164224
  buffer_load_dwordx4 v8, s[8:11], s30 offen lds
  v_mfma_f32_32x32x16_bf16 v[80:95], v[40:43], v[36:39], v[80:95]
  v_mfma_f32_32x32x16_bf16 v[96:111], v[44:47], v[32:35], v[96:111]
  s_add_u32 m0, s28, 24576
  s_add_u32 s30, s26, 246144
  buffer_load_dwordx4 v8, s[8:11], s30 offen lds
  v_mfma_f32_32x32x16_bf16 v[112:127], v[44:47], v[36:39], v[112:127]
  s_waitcnt lgkmcnt(0)
  ds_read_b128 v[32:35], v16 offset:0
  ds_read_b128 v[36:39], v16 offset:4096
  ds_read_b64_tr_b16 v[40:41], v24 offset:8192
  ds_read_b64_tr_b16 v[42:43], v24 offset:9216
  ds_read_b64_tr_b16 v[44:45], v25 offset:8192
  ds_read_b64_tr_b16 v[46:47], v25 offset:9216
  v_mfma_f32_32x32x16_bf16 v[64:79], v[56:59], v[48:51], v[64:79]
  s_add_u32 m0, s29, 0
  s_add_u32 s30, s27, 737280
  buffer_load_dwordx4 v9, s[12:15], s30 offen lds
  v_mfma_f32_32x32x16_bf16 v[80:95], v[56:59], v[52:55], v[80:95]
  v_mfma_f32_32x32x16_bf16 v[96:111], v[60:63], v[48:51], v[96:111]
  s_add_u32 m0, s29, 8192
  s_add_u32 s30, s27, 860160
  buffer_load_dwordx4 v9, s[12:15], s30 offen lds
  v_mfma_f32_32x32x16_bf16 v[112:127], v[60:63], v[52:55], v[112:127]
  s_waitcnt lgkmcnt(0)
  ds_read_b128 v[48:51], v17 offset:0
  ds_read_b128 v[52:55], v17 offset:4096
  ds_read_b64_tr_b16 v[56:57], v24 offset:12288
  ds_read_b64_tr_b16 v[58:59], v24 offset:13312
  ds_read_b64_tr_b16 v[60:61], v25 offset:12288
  ds_read_b64_tr_b16 v[62:63], v25 offset:13312
  v_mfma_f32_32x32x16_bf16 v[64:79], v[40:43], v[32:35], v[64:79]
  v_mfma_f32_32x32x16_bf16 v[80:95], v[40:43], v[36:39], v[80:95]
  v_mfma_f32_32x32x16_bf16 v[96:111], v[44:47], v[32:35], v[96:111]
  v_mfma_f32_32x32x16_bf16 v[112:127], v[44:47], v[36:39], v[112:127]
  s_waitcnt vmcnt(6) lgkmcnt(0)
  s_barrier
  ds_read_b128 v[32:35], v18 offset:0
  ds_read_b128 v[36:39], v18 offset:4096
  ds_read_b64_tr_b16 v[40:41], v26 offset:0
  ds_read_b64_tr_b16 v[42:43], v26 offset:1024
  ds_read_b64_tr_b16 v[44:45], v27 offset:0
  ds_read_b64_tr_b16 v[46:47], v27 offset:1024
  v_mfma_f32_32x32x16_bf16 v[64:79], v[56:59], v[48:51], v[64:79]
  s_add_u32 m0, s28, 49152
  s_add_u32 s30, s26, 512
  buffer_load_dwordx4 v8, s[8:11], s30 offen lds
  v_mfma_f32_32x32x16_bf16 v[80:95], v[56:59], v[52:55], v[80:95]
  v_mfma_f32_32x32x16_bf16 v[96:111], v[60:63], v[48:51], v[96:111]
  s_add_u32 m0, s28, 57344
  s_add_u32 s30, s26, 82432
  buffer_load_dwordx4 v8, s[8:11], s30 offen lds
  v_mfma_f32_32x32x16_bf16 v[112:127], v[60:63], v[52:55], v[112:127]
  s_waitcnt lgkmcnt(0)
  ds_read_b128 v[48:51], v19 offset:0
  ds_read_b128 v[52:55], v19 offset:4096
  ds_read_b64_tr_b16 v[56:57], v26 offset:4096
  ds_read_b64_tr_b16 v[58:59], v26 offset:5120
  ds_read_b64_tr_b16 v[60:61], v27 offset:4096
  ds_read_b64_tr_b16 v[62:63], v27 offset:5120
  v_mfma_f32_32x32x16_bf16 v[64:79], v[40:43], v[32:35], v[64:79]
  s_add_u32 m0, s28, 65536
  s_add_u32 s30, s26, 164352
  buffer_load_dwordx4 v8, s[8:11], s30 offen lds
  v_mfma_f32_32x32x16_bf16 v[80:95], v[40:43], v[36:39], v[80:95]
  v_mfma_f32_32x32x16_bf16 v[96:111], v[44:47], v[32:35], v[96:111]
  s_add_u32 m0, s28, 73728
  s_add_u32 s30, s26, 246272
  buffer_load_dwordx4 v8, s[8:11], s30 offen lds
  v_mfma_f32_32x32x16_bf16 v[112:127], v[44:47], v[36:39], v[112:127]
  s_waitcnt lgkmcnt(0)
  ds_read_b128 v[32:35], v20 offset:0
  ds_read_b128 v[36:39], v20 offset:4096
  ds_read_b64_tr_b16 v[40:41], v26 offset:8192
  ds_read_b64_tr_b16 v[42:43], v26 offset:9216
  ds_read_b64_tr_b16 v[44:45], v27 offset:8192
  ds_read_b64_tr_b16 v[46:47], v27 offset:9216
  v_mfma_f32_32x32x16_bf16 v[64:79], v[56:59], v[48:51], v[64:79]
  s_add_u32 m0, s29, 49152
  s_add_u32 s30, s27, 983040
  buffer_load_dwordx4 v9, s[12:15], s30 offen lds
  v_mfma_f32_32x32x16_bf16 v[80:95], v[56:59], v[52:55], v[80:95]
  v_mfma_f32_32x32x16_bf16 v[96:111], v[60:63], v[48:51], v[96:111]
  s_add_u32 m0, s29, 57344
  s_add_u32 s30, s27, 1105920
  buffer_load_dwordx4 v9, s[12:15], s30 offen lds
  v_mfma_f32_32x32x16_bf16 v[112:127], v[60:63], v[52:55], v[112:127]
  s_waitcnt lgkmcnt(0)
  ds_read_b128 v[48:51], v21 offset:0
  ds_read_b128 v[52:55], v21 offset:4096
  ds_read_b64_tr_b16 v[56:57], v26 offset:12288
  ds_read_b64_tr_b16 v[58:59], v26 offset:13312
  ds_read_b64_tr_b16 v[60:61], v27 offset:12288
  ds_read_b64_tr_b16 v[62:63], v27 offset:13312
  v_mfma_f32_32x32x16_bf16 v[64:79], v[40:43], v[32:35], v[64:79]
  v_mfma_f32_32x32x16_bf16 v[80:95], v[40:43], v[36:39], v[80:95]
  v_mfma_f32_32x32x16_bf16 v[96:111], v[44:47], v[32:35], v[96:111]
  v_mfma_f32_32x32x16_bf16 v[112:127], v[44:47], v[36:39], v[112:127]
  s_waitcnt vmcnt(6) lgkmcnt(0)
  s_barrier
  ds_read_b128 v[32:35], v10 offset:0
  ds_read_b128 v[36:39], v10 offset:4096
  ds_read_b64_tr_b16 v[40:41], v22 offset:0
  ds_read_b64_tr_b16 v[42:43], v22 offset:1024
  ds_read_b64_tr_b16 v[44:45], v23 offset:0
  ds_read_b64_tr_b16 v[46:47], v23 offset:1024
  v_mfma_f32_32x32x16_bf16 v[64:79], v[56:59], v[48:51], v[64:79]
  s_add_u32 m0, s28, 98304
  s_add_u32 s30, s26, 640
  buffer_load_dwordx4 v8, s[8:11], s30 offen lds
  v_mfma_f32_32x32x16_bf16 v[80:95], v[56:59], v[52:55], v[80:95]
  v_mfma_f32_32x32x16_bf16 v[96:111], v[60:63], v[48:51], v[96:111]
  s_add_u32 m0, s28, 106496
  s_add_u32 s30, s26, 82560
  buffer_load_dwordx4 v8, s[8:11], s30 offen lds
  v_mfma_f32_32x32x16_bf16 v[112:127], v[60:63], v[52:55], v[112:127]
  s_waitcnt lgkmcnt(0)
  ds_read_b128 v[48:51], v11 offset:0
  ds_read_b128 v[52:55], v11 offset:4096
  ds_read_b64_tr_b16 v[56:57], v22 offset:4096
  ds_read_b64_tr_b16 v[58:59], v22 offset:5120
  ds_read_b64_tr_b16 v[60:61], v23 offset:4096
  ds_read_b64_tr_b16 v[62:63], v23 offset:5120
  v_mfma_f32_32x32x16_bf16 v[64:79], v[40:43], v[32:35], v[64:79]
  s_add_u32 m0, s28, 114688
  s_add_u32 s30, s26, 164480
  buffer_load_dwordx4 v8, s[8:11], s30 offen lds
  v_mfma_f32_32x32x16_bf16 v[80:95], v[40:43], v[36:39], v[80:95]
  v_mfma_f32_32x32x16_bf16 v[96:111], v[44:47], v[32:35], v[96:111]
  s_add_u32 m0, s28, 122880
  s_add_u32 s30, s26, 246400
  buffer_load_dwordx4 v8, s[8:11], s30 offen lds
  v_mfma_f32_32x32x16_bf16 v[112:127], v[44:47], v[36:39], v[112:127]
  s_waitcnt lgkmcnt(0)
  ds_read_b128 v[32:35], v12 offset:0
  ds_read_b128 v[36:39], v12 offset:4096
  ds_read_b64_tr_b16 v[40:41], v22 offset:8192
  ds_read_b64_tr_b16 v[42:43], v22 offset:9216
  ds_read_b64_tr_b16 v[44:45], v23 offset:8192
  ds_read_b64_tr_b16 v[46:47], v23 offset:9216
  v_mfma_f32_32x32x16_bf16 v[64:79], v[56:59], v[48:51], v[64:79]
  s_add_u32 m0, s29, 98304
  s_add_u32 s30, s27, 1228800
  buffer_load_dwordx4 v9, s[12:15], s30 offen lds
  v_mfma_f32_32x32x16_bf16 v[80:95], v[56:59], v[52:55], v[80:95]
  v_mfma_f32_32x32x16_bf16 v[96:111], v[60:63], v[48:51], v[96:111]
  s_add_u32 m0, s29, 106496
  s_add_u32 s30, s27, 1351680
  buffer_load_dwordx4 v9, s[12:15], s30 offen lds
  v_mfma_f32_32x32x16_bf16 v[112:127], v[60:63], v[52:55], v[112:127]
  s_waitcnt lgkmcnt(0)
  ds_read_b128 v[48:51], v13 offset:0
  ds_read_b128 v[52:55], v13 offset:4096
  ds_read_b64_tr_b16 v[56:57], v22 offset:12288
  ds_read_b64_tr_b16 v[58:59], v22 offset:13312
  ds_read_b64_tr_b16 v[60:61], v23 offset:12288
  ds_read_b64_tr_b16 v[62:63], v23 offset:13312
  v_mfma_f32_32x32x16_bf16 v[64:79], v[40:43], v[32:35], v[64:79]
  v_mfma_f32_32x32x16_bf16 v[80:95], v[40:43], v[36:39], v[80:95]
  v_mfma_f32_32x32x16_bf16 v[96:111], v[44:47], v[32:35], v[96:111]
  v_mfma_f32_32x32x16_bf16 v[112:127], v[44:47], v[36:39], v[112:127]
  s_waitcnt vmcnt(6) lgkmcnt(0)
  s_barrier
  ds_read_b128 v[32:35], v14 offset:0
  ds_read_b128 v[36:39], v14 offset:4096
  ds_read_b64_tr_b16 v[40:41], v24 offset:0
  ds_read_b64_tr_b16 v[42:43], v24 offset:1024
  ds_read_b64_tr_b16 v[44:45], v25 offset:0
  ds_read_b64_tr_b16 v[46:47], v25 offset:1024
  v_mfma_f32_32x32x16_bf16 v[64:79], v[56:59], v[48:51], v[64:79]
  s_add_u32 m0, s28, 0
  s_add_u32 s30, s26, 768
  buffer_load_dwordx4 v8, s[8:11], s30 offen lds
  v_mfma_f32_32x32x16_bf16 v[80:95], v[56:59], v[52:55], v[80:95]
  v_mfma_f32_32x32x16_bf16 v[96:111], v[60:63], v[48:51], v[96:111]
  s_add_u32 m0, s28, 8192
  s_add_u32 s30, s26, 82688
  buffer_load_dwordx4 v8, s[8:11], s30 offen lds
  v_mfma_f32_32x32x16_bf16 v[112:127], v[60:63], v[52:55], v[112:127]
  s_waitcnt lgkmcnt(0)
  ds_read_b128 v[48:51], v15 offset:0
  ds_read_b128 v[52:55], v15 offset:4096
  ds_read_b64_tr_b16 v[56:57], v24 offset:4096
  ds_read_b64_tr_b16 v[58:59], v24 offset:5120
  ds_read_b64_tr_b16 v[60:61], v25 offset:4096
  ds_read_b64_tr_b16 v[62:63], v25 offset:5120
  v_mfma_f32_32x32x16_bf16 v[64:79], v[40:43], v[32:35], v[64:79]
  s_add_u32 m0, s28, 16384
  s_add_u32 s30, s26, 164608
  buffer_load_dwordx4 v8, s[8:11], s30 offen lds
  v_mfma_f32_32x32x16_bf16 v[80:95], v[40:43], v[36:39], v[80:95]
  v_mfma_f32_32x32x16_bf16 v[96:111], v[44:47], v[32:35], v[96:111]
  s_add_u32 m0, s28, 24576
  s_add_u32 s30, s26, 246528
  buffer_load_dwordx4 v8, s[8:11], s30 offen lds
  v_mfma_f32_32x32x16_bf16 v[112:127], v[44:47], v[36:39], v[112:127]
  s_waitcnt lgkmcnt(0)
  ds_read_b128 v[32:35], v16 offset:0
  ds_read_b128 v[36:39], v16 offset:4096
  ds_read_b64_tr_b16 v[40:41], v24 offset:8192
  ds_read_b64_tr_b16 v[42:43], v24 offset:9216
  ds_read_b64_tr_b16 v[44:45], v25 offset:8192
  ds_read_b64_tr_b16 v[46:47], v25 offset:9216
  v_mfma_f32_32x32x16_bf16 v[64:79], v[56:59], v[48:51], v[64:79]
  s_add_u32 m0, s29, 0
  s_add_u32 s30, s27, 1474560
  buffer_load_dwordx4 v9, s[12:15], s30 offen lds
  v_mfma_f32_32x32x16_bf16 v[80:95], v[56:59], v[52:55], v[80:95]
  v_mfma_f32_32x32x16_bf16 v[96:111], v[60:63], v[48:51], v[96:111]
  s_add_u32 m0, s29, 8192
  s_add_u32 s30, s27, 1597440
  buffer_load_dwordx4 v9, s[12:15], s30 offen lds
  v_mfma_f32_32x32x16_bf16 v[112:127], v[60:63], v[52:55], v[112:127]
  s_waitcnt lgkmcnt(0)
  ds_read_b128 v[48:51], v17 offset:0
  ds_read_b128 v[52:55], v17 offset:4096
  ds_read_b64_tr_b16 v[56:57], v24 offset:12288
  ds_read_b64_tr_b16 v[58:59], v24 offset:13312
  ds_read_b64_tr_b16 v[60:61], v25 offset:12288
  ds_read_b64_tr_b16 v[62:63], v25 offset:13312
  v_mfma_f32_32x32x16_bf16 v[64:79], v[40:43], v[32:35], v[64:79]
  v_mfma_f32_32x32x16_bf16 v[80:95], v[40:43], v[36:39], v[80:95]
  v_mfma_f32_32x32x16_bf16 v[96:111], v[44:47], v[32:35], v[96:111]
  v_mfma_f32_32x32x16_bf16 v[112:127], v[44:47], v[36:39], v[112:127]
  s_waitcnt vmcnt(6) lgkmcnt(0)
  s_barrier
  ds_read_b128 v[32:35], v18 offset:0
  ds_read_b128 v[36:39], v18 offset:4096
  ds_read_b64_tr_b16 v[40:41], v26 offset:0
  ds_read_b64_tr_b16 v[42:43], v26 offset:1024
  ds_read_b64_tr_b16 v[44:45], v27 offset:0
  ds_read_b64_tr_b16 v[46:47], v27 offset:1024
  v_mfma_f32_32x32x16_bf16 v[64:79], v[56:59], v[48:51], v[64:79]
  s_add_u32 m0, s28, 49152
  s_add_u32 s30, s26, 896
  buffer_load_dwordx4 v8, s[8:11], s30 offen lds
  v_mfma_f32_32x32x16_bf16 v[80:95], v[56:59], v[52:55], v[80:95]
  v_mfma_f32_32x32x16_bf16 v[96:111], v[60:63], v[48:51], v[96:111]
  s_add_u32 m0, s28, 57344
  s_add_u32 s30, s26, 82816
  buffer_load_dwordx4 v8, s[8:11], s30 offen lds
  v_mfma_f32_32x32x16_bf16 v[112:127], v[60:63], v[52:55], v[112:127]
  s_waitcnt lgkmcnt(0)
  ds_read_b128 v[48:51], v19 offset:0
  ds_read_b128 v[52:55], v19 offset:4096
  ds_read_b64_tr_b16 v[56:57], v26 offset:4096
  ds_read_b64_tr_b16 v[58:59], v26 offset:5120
  ds_read_b64_tr_b16 v[60:61], v27 offset:4096
  ds_read_b64_tr_b16 v[62:63], v27 offset:5120
  v_mfma_f32_32x32x16_bf16 v[64:79], v[40:43], v[32:35], v[64:79]
  s_add_u32 m0, s28, 65536
  s_add_u32 s30, s26, 164736
  buffer_load_dwordx4 v8, s[8:11], s30 offen lds
  v_mfma_f32_32x32x16_bf16 v[80:95], v[40:43], v[36:39], v[80:95]
  v_mfma_f32_32x32x16_bf16 v[96:111], v[44:47], v[32:35], v[96:111]
  s_add_u32 m0, s28, 73728
  s_add_u32 s30, s26, 246656
  buffer_load_dwordx4 v8, s[8:11], s30 offen lds
  v_mfma_f32_32x32x16_bf16 v[112:127], v[44:47], v[36:39], v[112:127]
  s_waitcnt lgkmcnt(0)
  ds_read_b128 v[32:35], v20 offset:0
  ds_read_b128 v[36:39], v20 offset:4096
  ds_read_b64_tr_b16 v[40:41], v26 offset:8192
  ds_read_b64_tr_b16 v[42:43], v26 offset:9216
  ds_read_b64_tr_b16 v[44:45], v27 offset:8192
  ds_read_b64_tr_b16 v[46:47], v27 offset:9216
  v_mfma_f32_32x32x16_bf16 v[64:79], v[56:59], v[48:51], v[64:79]
  s_add_u32 m0, s29, 49152
  s_add_u32 s30, s27, 1720320
  buffer_load_dwordx4 v9, s[12:15], s30 offen lds
  v_mfma_f32_32x32x16_bf16 v[80:95], v[56:59], v[52:55], v[80:95]
  v_mfma_f32_32x32x16_bf16 v[96:111], v[60:63], v[48:51], v[96:111]
  s_add_u32 m0, s29, 57344
  s_add_u32 s30, s27, 1843200
  buffer_load_dwordx4 v9, s[12:15], s30 offen lds
  v_mfma_f32_32x32x16_bf16 v[112:127], v[60:63], v[52:55], v[112:127]
  s_waitcnt lgkmcnt(0)
  ds_read_b128 v[48:51], v21 offset:0
  ds_read_b128 v[52:55], v21 offset:4096
  ds_read_b64_tr_b16 v[56:57], v26 offset:12288
  ds_read_b64_tr_b16 v[58:59], v26 offset:13312
  ds_read_b64_tr_b16 v[60:61], v27 offset:12288
  ds_read_b64_tr_b16 v[62:63], v27 offset:13312
  v_mfma_f32_32x32x16_bf16 v[64:79], v[40:43], v[32:35], v[64:79]
  v_mfma_f32_32x32x16_bf16 v[80:95], v[40:43], v[36:39], v[80:95]
  v_mfma_f32_32x32x16_bf16 v[96:111], v[44:47], v[32:35], v[96:111]
  v_mfma_f32_32x32x16_bf16 v[112:127], v[44:47], v[36:39], v[112:127]
  s_waitcnt vmcnt(6) lgkmcnt(0)
  s_barrier
  ds_read_b128 v[32:35], v10 offset:0
  ds_read_b128 v[36:39], v10 offset:4096
  ds_read_b64_tr_b16 v[40:41], v22 offset:0
  ds_read_b64_tr_b16 v[42:43], v22 offset:1024
  ds_read_b64_tr_b16 v[44:45], v23 offset:0
  ds_read_b64_tr_b16 v[46:47], v23 offset:1024
  v_mfma_f32_32x32x16_bf16 v[64:79], v[56:59], v[48:51], v[64:79]
  s_add_u32 m0, s28, 98304
  s_add_u32 s30, s26, 1024
  buffer_load_dwordx4 v8, s[8:11], s30 offen lds
  v_mfma_f32_32x32x16_bf16 v[80:95], v[56:59], v[52:55], v[80:95]
  v_mfma_f32_32x32x16_bf16 v[96:111], v[60:63], v[48:51], v[96:111]
  s_add_u32 m0, s28, 106496
  s_add_u32 s30, s26, 82944
  buffer_load_dwordx4 v8, s[8:11], s30 offen lds
  v_mfma_f32_32x32x16_bf16 v[112:127], v[60:63], v[52:55], v[112:127]
  s_waitcnt lgkmcnt(0)
  ds_read_b128 v[48:51], v11 offset:0
  ds_read_b128 v[52:55], v11 offset:4096
  ds_read_b64_tr_b16 v[56:57], v22 offset:4096
  ds_read_b64_tr_b16 v[58:59], v22 offset:5120
  ds_read_b64_tr_b16 v[60:61], v23 offset:4096
  ds_read_b64_tr_b16 v[62:63], v23 offset:5120
  v_mfma_f32_32x32x16_bf16 v[64:79], v[40:43], v[32:35], v[64:79]
  s_add_u32 m0, s28, 114688
  s_add_u32 s30, s26, 164864
  buffer_load_dwordx4 v8, s[8:11], s30 offen lds
  v_mfma_f32_32x32x16_bf16 v[80:95], v[40:43], v[36:39], v[80:95]
  v_mfma_f32_32x32x16_bf16 v[96:111], v[44:47], v[32:35], v[96:111]
  s_add_u32 m0, s28, 122880
  s_add_u32 s30, s26, 246784
  buffer_load_dwordx4 v8, s[8:11], s30 offen lds
  v_mfma_f32_32x32x16_bf16 v[112:127], v[44:47], v[36:39], v[112:127]
  s_waitcnt lgkmcnt(0)
  ds_read_b128 v[32:35], v12 offset:0
  ds_read_b128 v[36:39], v12 offset:4096
  ds_read_b64_tr_b16 v[40:41], v22 offset:8192
  ds_read_b64_tr_b16 v[42:43], v22 offset:9216
  ds_read_b64_tr_b16 v[44:45], v23 offset:8192
  ds_read_b64_tr_b16 v[46:47], v23 offset:9216
  v_mfma_f32_32x32x16_bf16 v[64:79], v[56:59], v[48:51], v[64:79]
  s_add_u32 m0, s29, 98304
  s_add_u32 s30, s27, 1966080
  buffer_load_dwordx4 v9, s[12:15], s30 offen lds
  v_mfma_f32_32x32x16_bf16 v[80:95], v[56:59], v[52:55], v[80:95]
  v_mfma_f32_32x32x16_bf16 v[96:111], v[60:63], v[48:51], v[96:111]
  s_add_u32 m0, s29, 106496
  s_add_u32 s30, s27, 2088960
  buffer_load_dwordx4 v9, s[12:15], s30 offen lds
  v_mfma_f32_32x32x16_bf16 v[112:127], v[60:63], v[52:55], v[112:127]
  s_waitcnt lgkmcnt(0)
  ds_read_b128 v[48:51], v13 offset:0
  ds_read_b128 v[52:55], v13 offset:4096
  ds_read_b64_tr_b16 v[56:57], v22 offset:12288
  ds_read_b64_tr_b16 v[58:59], v22 offset:13312
  ds_read_b64_tr_b16 v[60:61], v23 offset:12288
  ds_read_b64_tr_b16 v[62:63], v23 offset:13312
  v_mfma_f32_32x32x16_bf16 v[64:79], v[40:43], v[32:35], v[64:79]
  v_mfma_f32_32x32x16_bf16 v[80:95], v[40:43], v[36:39], v[80:95]
  v_mfma_f32_32x32x16_bf16 v[96:111], v[44:47], v[32:35], v[96:111]
  v_mfma_f32_32x32x16_bf16 v[112:127], v[44:47], v[36:39], v[112:127]
  s_waitcnt vmcnt(6) lgkmcnt(0)
  s_barrier
  ds_read_b128 v[32:35], v14 offset:0
  ds_read_b128 v[36:39], v14 offset:4096
  ds_read_b64_tr_b16 v[40:41], v24 offset:0
  ds_read_b64_tr_b16 v[42:43], v24 offset:1024
  ds_read_b64_tr_b16 v[44:45], v25 offset:0
  ds_read_b64_tr_b16 v[46:47], v25 offset:1024
  v_mfma_f32_32x32x16_bf16 v[64:79], v[56:59], v[48:51], v[64:79]
  s_add_u32 m0, s28, 0
  s_add_u32 s30, s26, 1152
  buffer_load_dwordx4 v8, s[8:11], s30 offen lds
  v_mfma_f32_32x32x16_bf16 v[80:95], v[56:59], v[52:55], v[80:95]
  v_mfma_f32_32x32x16_bf16 v[96:111], v[60:63], v[48:51], v[96:111]
  s_add_u32 m0, s28, 8192
  s_add_u32 s30, s26, 83072
  buffer_load_dwordx4 v8, s[8:11], s30 offen lds
  v_mfma_f32_32x32x16_bf16 v[112:127], v[60:63], v[52:55], v[112:127]
  s_waitcnt lgkmcnt(0)
  ds_read_b128 v[48:51], v15 offset:0
  ds_read_b128 v[52:55], v15 offset:4096
  ds_read_b64_tr_b16 v[56:57], v24 offset:4096
  ds_read_b64_tr_b16 v[58:59], v24 offset:5120
  ds_read_b64_tr_b16 v[60:61], v25 offset:4096
  ds_read_b64_tr_b16 v[62:63], v25 offset:5120
  v_mfma_f32_32x32x16_bf16 v[64:79], v[40:43], v[32:35], v[64:79]
  s_add_u32 m0, s28, 16384
  s_add_u32 s30, s26, 164992
  buffer_load_dwordx4 v8, s[8:11], s30 offen lds
  v_mfma_f32_32x32x16_bf16 v[80:95], v[40:43], v[36:39], v[80:95]
  v_mfma_f32_32x32x16_bf16 v[96:111], v[44:47], v[32:35], v[96:111]
  s_add_u32 m0, s28, 24576
  s_add_u32 s30, s26, 246912
  buffer_load_dwordx4 v8, s[8:11], s30 offen lds
  v_mfma_f32_32x32x16_bf16 v[112:127], v[44:47], v[36:39], v[112:127]
  s_waitcnt lgkmcnt(0)
  ds_read_b128 v[32:35], v16 offset:0
  ds_read_b128 v[36:39], v16 offset:4096
  ds_read_b64_tr_b16 v[40:41], v24 offset:8192
  ds_read_b64_tr_b16 v[42:43], v24 offset:9216
  ds_read_b64_tr_b16 v[44:45], v25 offset:8192
  ds_read_b64_tr_b16 v[46:47], v25 offset:9216
  v_mfma_f32_32x32x16_bf16 v[64:79], v[56:59], v[48:51], v[64:79]
  s_add_u32 m0, s29, 0
  s_add_u32 s30, s27, 2211840
  buffer_load_dwordx4 v9, s[12:15], s30 offen lds
  v_mfma_f32_32x32x16_bf16 v[80:95], v[56:59], v[52:55], v[80:95]
  v_mfma_f32_32x32x16_bf16 v[96:111], v[60:63], v[48:51], v[96:111]
  s_add_u32 m0, s29, 8192
  s_add_u32 s30, s27, 2334720
  buffer_load_dwordx4 v9, s[12:15], s30 offen lds
  v_mfma_f32_32x32x16_bf16 v[112:127], v[60:63], v[52:55], v[112:127]
  s_waitcnt lgkmcnt(0)
  ds_read_b128 v[48:51], v17 offset:0
  ds_read_b128 v[52:55], v17 offset:4096
  ds_read_b64_tr_b16 v[56:57], v24 offset:12288
  ds_read_b64_tr_b16 v[58:59], v24 offset:13312
  ds_read_b64_tr_b16 v[60:61], v25 offset:12288
  ds_read_b64_tr_b16 v[62:63], v25 offset:13312
  v_mfma_f32_32x32x16_bf16 v[64:79], v[40:43], v[32:35], v[64:79]
  v_mfma_f32_32x32x16_bf16 v[80:95], v[40:43], v[36:39], v[80:95]
  v_mfma_f32_32x32x16_bf16 v[96:111], v[44:47], v[32:35], v[96:111]
  v_mfma_f32_32x32x16_bf16 v[112:127], v[44:47], v[36:39], v[112:127]
  s_waitcnt vmcnt(6) lgkmcnt(0)
  s_barrier
  ds_read_b128 v[32:35], v18 offset:0
  ds_read_b128 v[36:39], v18 offset:4096
  ds_read_b64_tr_b16 v[40:41], v26 offset:0
  ds_read_b64_tr_b16 v[42:43], v26 offset:1024
  ds_read_b64_tr_b16 v[44:45], v27 offset:0
  ds_read_b64_tr_b16 v[46:47], v27 offset:1024
  v_mfma_f32_32x32x16_bf16 v[64:79], v[56:59], v[48:51], v[64:79]
  v_mfma_f32_32x32x16_bf16 v[80:95], v[56:59], v[52:55], v[80:95]
  v_mfma_f32_32x32x16_bf16 v[96:111], v[60:63], v[48:51], v[96:111]
  v_mfma_f32_32x32x16_bf16 v[112:127], v[60:63], v[52:55], v[112:127]
  s_waitcnt lgkmcnt(0)
  ds_read_b128 v[48:51], v19 offset:0
  ds_read_b128 v[52:55], v19 offset:4096
  ds_read_b64_tr_b16 v[56:57], v26 offset:4096
  ds_read_b64_tr_b16 v[58:59], v26 offset:5120
  ds_read_b64_tr_b16 v[60:61], v27 offset:4096
  ds_read_b64_tr_b16 v[62:63], v27 offset:5120
  v_mfma_f32_32x32x16_bf16 v[64:79], v[40:43], v[32:35], v[64:79]
  v_mfma_f32_32x32x16_bf16 v[80:95], v[40:43], v[36:39], v[80:95]
  v_mfma_f32_32x32x16_bf16 v[96:111], v[44:47], v[32:35], v[96:111]
  v_mfma_f32_32x32x16_bf16 v[112:127], v[44:47], v[36:39], v[112:127]
  s_waitcnt lgkmcnt(0)
  ds_read_b128 v[32:35], v20 offset:0
  ds_read_b128 v[36:39], v20 offset:4096
  ds_read_b64_tr_b16 v[40:41], v26 offset:8192
  ds_read_b64_tr_b16 v[42:43], v26 offset:9216
  ds_read_b64_tr_b16 v[44:45], v27 offset:8192
  ds_read_b64_tr_b16 v[46:47], v27 offset:9216
  v_mfma_f32_32x32x16_bf16 v[64:79], v[56:59], v[48:51], v[64:79]
  v_mfma_f32_32x32x16_bf16 v[80:95], v[56:59], v[52:55], v[80:95]
  v_mfma_f32_32x32x16_bf16 v[96:111], v[60:63], v[48:51], v[96:111]
  v_mfma_f32_32x32x16_bf16 v[112:127], v[60:63], v[52:55], v[112:127]
  s_waitcnt lgkmcnt(0)
  ds_read_b128 v[48:51], v21 offset:0
  ds_read_b128 v[52:55], v21 offset:4096
  ds_read_b64_tr_b16 v[56:57], v26 offset:12288
  ds_read_b64_tr_b16 v[58:59], v26 offset:13312
  ds_read_b64_tr_b16 v[60:61], v27 offset:12288
  ds_read_b64_tr_b16 v[62:63], v27 offset:13312
  v_mfma_f32_32x32x16_bf16 v[64:79], v[40:43], v[32:35], v[64:79]
  v_mfma_f32_32x32x16_bf16 v[80:95], v[40:43], v[36:39], v[80:95]
  v_mfma_f32_32x32x16_bf16 v[96:111], v[44:47], v[32:35], v[96:111]
  v_mfma_f32_32x32x16_bf16 v[112:127], v[44:47], v[36:39], v[112:127]
  s_waitcnt vmcnt(0) lgkmcnt(0)
  s_barrier
  ds_read_b128 v[32:35], v10 offset:0
  ds_read_b128 v[36:39], v10 offset:4096
  ds_read_b64_tr_b16 v[40:41], v22 offset:0
  ds_read_b64_tr_b16 v[42:43], v22 offset:1024
  ds_read_b64_tr_b16 v[44:45], v23 offset:0
  ds_read_b64_tr_b16 v[46:47], v23 offset:1024
  v_mfma_f32_32x32x16_bf16 v[64:79], v[56:59], v[48:51], v[64:79]
  v_mfma_f32_32x32x16_bf16 v[80:95], v[56:59], v[52:55], v[80:95]
  v_mfma_f32_32x32x16_bf16 v[96:111], v[60:63], v[48:51], v[96:111]
  v_mfma_f32_32x32x16_bf16 v[112:127], v[60:63], v[52:55], v[112:127]
  s_waitcnt lgkmcnt(0)
  ds_read_b128 v[48:51], v11 offset:0
  ds_read_b128 v[52:55], v11 offset:4096
  ds_read_b64_tr_b16 v[56:57], v22 offset:4096
  ds_read_b64_tr_b16 v[58:59], v22 offset:5120
  ds_read_b64_tr_b16 v[60:61], v23 offset:4096
  ds_read_b64_tr_b16 v[62:63], v23 offset:5120
  v_mfma_f32_32x32x16_bf16 v[64:79], v[40:43], v[32:35], v[64:79]
  v_mfma_f32_32x32x16_bf16 v[80:95], v[40:43], v[36:39], v[80:95]
  v_mfma_f32_32x32x16_bf16 v[96:111], v[44:47], v[32:35], v[96:111]
  v_mfma_f32_32x32x16_bf16 v[112:127], v[44:47], v[36:39], v[112:127]
  s_waitcnt lgkmcnt(0)
  ds_read_b128 v[32:35], v12 offset:0
  ds_read_b128 v[36:39], v12 offset:4096
  ds_read_b64_tr_b16 v[40:41], v22 offset:8192
  ds_read_b64_tr_b16 v[42:43], v22 offset:9216
  ds_read_b64_tr_b16 v[44:45], v23 offset:8192
  ds_read_b64_tr_b16 v[46:47], v23 offset:9216
  v_mfma_f32_32x32x16_bf16 v[64:79], v[56:59], v[48:51], v[64:79]
  v_mfma_f32_32x32x16_bf16 v[80:95], v[56:59], v[52:55], v[80:95]
  v_mfma_f32_32x32x16_bf16 v[96:111], v[60:63], v[48:51], v[96:111]
  v_mfma_f32_32x32x16_bf16 v[112:127], v[60:63], v[52:55], v[112:127]
  s_waitcnt lgkmcnt(0)
  ds_read_b128 v[48:51], v13 offset:0
  ds_read_b128 v[52:55], v13 offset:4096
  ds_read_b64_tr_b16 v[56:57], v22 offset:12288
  ds_read_b64_tr_b16 v[58:59], v22 offset:13312
  ds_read_b64_tr_b16 v[60:61], v23 offset:12288
  ds_read_b64_tr_b16 v[62:63], v23 offset:13312
  v_mfma_f32_32x32x16_bf16 v[64:79], v[40:43], v[32:35], v[64:79]
  v_mfma_f32_32x32x16_bf16 v[80:95], v[40:43], v[36:39], v[80:95]
  v_mfma_f32_32x32x16_bf16 v[96:111], v[44:47], v[32:35], v[96:111]
  v_mfma_f32_32x32x16_bf16 v[112:127], v[44:47], v[36:39], v[112:127]
  s_waitcnt lgkmcnt(0)
  v_mfma_f32_32x32x16_bf16 v[64:79], v[56:59], v[48:51], v[64:79]
  v_mfma_f32_32x32x16_bf16 v[80:95], v[56:59], v[52:55], v[80:95]
  v_mfma_f32_32x32x16_bf16 v[96:111], v[60:63], v[48:51], v[96:111]
  v_mfma_f32_32x32x16_bf16 v[112:127], v[60:63], v[52:55], v[112:127]
  s_lshr_b32 s3, s25, 2
  s_lshl_b32 s3, s3, 3
  s_lshl_b32 s30, s24, 4
  s_add_u32 s3, s3, s30
  v_add_u32 v4, s3, v3
  s_and_b32 s31, s25, 3
  s_lshl_b32 s31, s31, 1
  s_lshl_b32 s30, s21, 3
  s_add_u32 s31, s31, s30
  s_mul_i32 s26, s23, 2621440
  s_cmp_eq_u32 s20, 0
  s_cbranch_scc0 L_qkv_kernel_epiB
  v_lshlrev_b32 v8, 4, v2
  s_mul_i32 s31, s31, 2560
  s_add_u32 s26, s26, s31
  s_mov_b32 s27, 2560
  v_add_u32 v5, 0, v4
  v_mul_u32_u24 v6, 205, v5
  v_lshrrev_b32 v6, 10, v6
  v_mul_u32_u24 v7, 5, v6
  v_sub_u32 v5, v5, v7
  v_mul_u32_u24 v6, 163840, v6
  v_mul_u32_u24 v5, 512, v5
  v_add3_u32 v28, v5, v6, v8
  v_add_u32 v5, 2, v4
  v_mul_u32_u24 v6, 205, v5
  v_lshrrev_b32 v6, 10, v6
  v_mul_u32_u24 v7, 5, v6
  v_sub_u32 v5, v5, v7
  v_mul_u32_u24 v6, 163840, v6
  v_mul_u32_u24 v5, 512, v5
  v_add3_u32 v29, v5, v6, v8
  v_add_u32 v5, 4, v4
  v_mul_u32_u24 v6, 205, v5
  v_lshrrev_b32 v6, 10, v6
  v_mul_u32_u24 v7, 5, v6
  v_sub_u32 v5, v5, v7
  v_mul_u32_u24 v6, 163840, v6
  v_mul_u32_u24 v5, 512, v5
  v_add3_u32 v30, v5, v6, v8
  v_add_u32 v5, 6, v4
  v_mul_u32_u24 v6, 205, v5
  v_lshrrev_b32 v6, 10, v6
  v_mul_u32_u24 v7, 5, v6
  v_sub_u32 v5, v5, v7
  v_mul_u32_u24 v6, 163840, v6
  v_mul_u32_u24 v5, 512, v5
  v_add3_u32 v31, v5, v6, v8
  s_branch L_qkv_kernel_epiQK
L_qkv_kernel_epiB:
  v_lshrrev_b32 v5, 4, v2
  v_mul_u32_u24 v5, 81920, v5
  v_and_b32 v6, 15, v2
  v_lshl_add_u32 v8, v6, 4, v5
  s_lshl_b32 s31, s31, 8
  s_add_u32 s26, s26, s31
  s_add_u32 s26, s26, 7864320
  s_mov_b32 s27, 256
  v_add_u32 v5, 0, v4
  v_mul_u32_u24 v6, 205, v5
  v_lshrrev_b32 v6, 10, v6
  v_mul_u32_u24 v7, 5, v6
  v_sub_u32 v5, v5, v7
  v_mul_u32_u24 v6, 163840, v6
  v_mul_u32_u24 v5, 16384, v5
  v_add3_u32 v28, v5, v6, v8
  v_add_u32 v5, 2, v4
  v_mul_u32_u24 v6, 205, v5
  v_lshrrev_b32 v6, 10, v6
  v_mul_u32_u24 v7, 5, v6
  v_sub_u32 v5, v5, v7
  v_mul_u32_u24 v6, 163840, v6
  v_mul_u32_u24 v5, 16384, v5
  v_add3_u32 v29, v5, v6, v8
  v_add_u32 v5, 4, v4
  v_mul_u32_u24 v6, 205, v5
  v_lshrrev_b32 v6, 10, v6
  v_mul_u32_u24 v7, 5, v6
  v_sub_u32 v5, v5, v7
  v_mul_u32_u24 v6, 163840, v6
  v_mul_u32_u24 v5, 16384, v5
  v_add3_u32 v30, v5, v6, v8
  v_add_u32 v5, 6, v4
  v_mul_u32_u24 v6, 205, v5
  v_lshrrev_b32 v6, 10, v6
  v_mul_u32_u24 v7, 5, v6
  v_sub_u32 v5, v5, v7
  v_mul_u32_u24 v6, 163840, v6
  v_mul_u32_u24 v5, 16384, v5
  v_add3_u32 v31, v5, v6, v8
L_qkv_kernel_epiQK:
  s_add_u32 s27, s27, s26
  s_mov_b32 s30, 1.0
  s_cmp_eq_u32 s23, 0
  s_cselect_b32 s30, 1051011932, s30
  s_nop 7
  v_mul_f32 v64, s30, v64
  v_mul_f32 v65, s30, v65
  v_mul_f32 v66, s30, v66
  v_mul_f32 v67, s30, v67
  v_mul_f32 v68, s30, v68
  v_mul_f32 v69, s30, v69
  v_mul_f32 v70, s30, v70
  v_mul_f32 v71, s30, v71
  v_cvt_pk_bf16_f32 v64, v64, v65
  v_cvt_pk_bf16_f32 v65, v66, v67
  v_cvt_pk_bf16_f32 v66, v68, v69
  v_cvt_pk_bf16_f32 v67, v70, v71
  buffer_store_dwordx4 v[64:67], v28, s[16:19], s26 offen sc1
  v_mul_f32 v72, s30, v72
  v_mul_f32 v73, s30, v73
  v_mul_f32 v74, s30, v74
  v_mul_f32 v75, s30, v75
  v_mul_f32 v76, s30, v76
  v_mul_f32 v77, s30, v77
  v_mul_f32 v78, s30, v78
  v_mul_f32 v79, s30, v79
  v_cvt_pk_bf16_f32 v72, v72, v73
  v_cvt_pk_bf16_f32 v73, v74, v75
  v_cvt_pk_bf16_f32 v74, v76, v77
  v_cvt_pk_bf16_f32 v75, v78, v79
  buffer_store_dwordx4 v[72:75], v29, s[16:19], s26 offen sc1
  v_mul_f32 v80, s30, v80
  v_mul_f32 v81, s30, v81
  v_mul_f32 v82, s30, v82
  v_mul_f32 v83, s30, v83
  v_mul_f32 v84, s30, v84
  v_mul_f32 v85, s30, v85
  v_mul_f32 v86, s30, v86
  v_mul_f32 v87, s30, v87
  v_cvt_pk_bf16_f32 v80, v80, v81
  v_cvt_pk_bf16_f32 v81, v82, v83
  v_cvt_pk_bf16_f32 v82, v84, v85
  v_cvt_pk_bf16_f32 v83, v86, v87
  buffer_store_dwordx4 v[80:83], v28, s[16:19], s27 offen sc1
  v_mul_f32 v88, s30, v88
  v_mul_f32 v89, s30, v89
  v_mul_f32 v90, s30, v90
  v_mul_f32 v91, s30, v91
  v_mul_f32 v92, s30, v92
  v_mul_f32 v93, s30, v93
  v_mul_f32 v94, s30, v94
  v_mul_f32 v95, s30, v95
  v_cvt_pk_bf16_f32 v88, v88, v89
  v_cvt_pk_bf16_f32 v89, v90, v91
  v_cvt_pk_bf16_f32 v90, v92, v93
  v_cvt_pk_bf16_f32 v91, v94, v95
  buffer_store_dwordx4 v[88:91], v29, s[16:19], s27 offen sc1
  v_mul_f32 v96, s30, v96
  v_mul_f32 v97, s30, v97
  v_mul_f32 v98, s30, v98
  v_mul_f32 v99, s30, v99
  v_mul_f32 v100, s30, v100
  v_mul_f32 v101, s30, v101
  v_mul_f32 v102, s30, v102
  v_mul_f32 v103, s30, v103
  v_cvt_pk_bf16_f32 v96, v96, v97
  v_cvt_pk_bf16_f32 v97, v98, v99
  v_cvt_pk_bf16_f32 v98, v100, v101
  v_cvt_pk_bf16_f32 v99, v102, v103
  buffer_store_dwordx4 v[96:99], v30, s[16:19], s26 offen sc1
  v_mul_f32 v104, s30, v104
  v_mul_f32 v105, s30, v105
  v_mul_f32 v106, s30, v106
  v_mul_f32 v107, s30, v107
  v_mul_f32 v108, s30, v108
  v_mul_f32 v109, s30, v109
  v_mul_f32 v110, s30, v110
  v_mul_f32 v111, s30, v111
  v_cvt_pk_bf16_f32 v104, v104, v105
  v_cvt_pk_bf16_f32 v105, v106, v107
  v_cvt_pk_bf16_f32 v106, v108, v109
  v_cvt_pk_bf16_f32 v107, v110, v111
  buffer_store_dwordx4 v[104:107], v31, s[16:19], s26 offen sc1
  v_mul_f32 v112, s30, v112
  v_mul_f32 v113, s30, v113
  v_mul_f32 v114, s30, v114
  v_mul_f32 v115, s30, v115
  v_mul_f32 v116, s30, v116
  v_mul_f32 v117, s30, v117
  v_mul_f32 v118, s30, v118
  v_mul_f32 v119, s30, v119
  v_cvt_pk_bf16_f32 v112, v112, v113
  v_cvt_pk_bf16_f32 v113, v114, v115
  v_cvt_pk_bf16_f32 v114, v116, v117
  v_cvt_pk_bf16_f32 v115, v118, v119
  buffer_store_dwordx4 v[112:115], v30, s[16:19], s27 offen sc1
  v_mul_f32 v120, s30, v120
  v_mul_f32 v121, s30, v121
  v_mul_f32 v122, s30, v122
  v_mul_f32 v123, s30, v123
  v_mul_f32 v124, s30, v124
  v_mul_f32 v125, s30, v125
  v_mul_f32 v126, s30, v126
  v_mul_f32 v127, s30, v127
  v_cvt_pk_bf16_f32 v120, v120, v121
  v_cvt_pk_bf16_f32 v121, v122, v123
  v_cvt_pk_bf16_f32 v122, v124, v125
  v_cvt_pk_bf16_f32 v123, v126, v127
  buffer_store_dwordx4 v[120:123], v31, s[16:19], s27 offen sc1
  s_branch L_qkv_kernel_end
L_qkv_kernel_vform:
  s_waitcnt vmcnt(6) lgkmcnt(0)
  s_barrier
  ds_read_b128 v[32:35], v10 offset:0
  ds_read_b128 v[36:39], v10 offset:4096
  ds_read_b64_tr_b16 v[40:41], v22 offset:0
  ds_read_b64_tr_b16 v[42:43], v22 offset:1024
  ds_read_b64_tr_b16 v[44:45], v23 offset:0
  ds_read_b64_tr_b16 v[46:47], v23 offset:1024
  s_add_u32 m0, s28, 98304
  s_add_u32 s30, s26, 256
  buffer_load_dwordx4 v8, s[8:11], s30 offen lds
  s_add_u32 m0, s28, 106496
  s_add_u32 s30, s26, 82176
  buffer_load_dwordx4 v8, s[8:11], s30 offen lds
  s_waitcnt lgkmcnt(0)
  ds_read_b128 v[48:51], v11 offset:0
  ds_read_b128 v[52:55], v11 offset:4096
  ds_read_b64_tr_b16 v[56:57], v22 offset:4096
  ds_read_b64_tr_b16 v[58:59], v22 offset:5120
  ds_read_b64_tr_b16 v[60:61], v23 offset:4096
  ds_read_b64_tr_b16 v[62:63], v23 offset:5120
  v_mfma_f32_32x32x16_bf16 v[64:79], v[32:35], v[40:43], v[64:79]
  s_add_u32 m0, s28, 114688
  s_add_u32 s30, s26, 164096
  buffer_load_dwordx4 v8, s[8:11], s30 offen lds
  v_mfma_f32_32x32x16_bf16 v[80:95], v[36:39], v[40:43], v[80:95]
  v_mfma_f32_32x32x16_bf16 v[96:111], v[32:35], v[44:47], v[96:111]
  s_add_u32 m0, s28, 122880
  s_add_u32 s30, s26, 246016
  buffer_load_dwordx4 v8, s[8:11], s30 offen lds
  v_mfma_f32_32x32x16_bf16 v[112:127], v[36:39], v[44:47], v[112:127]
  s_waitcnt lgkmcnt(0)
  ds_read_b128 v[32:35], v12 offset:0
  ds_read_b128 v[36:39], v12 offset:4096
  ds_read_b64_tr_b16 v[40:41], v22 offset:8192
  ds_read_b64_tr_b16 v[42:43], v22 offset:9216
  ds_read_b64_tr_b16 v[44:45], v23 offset:8192
  ds_read_b64_tr_b16 v[46:47], v23 offset:9216
  v_mfma_f32_32x32x16_bf16 v[64:79], v[48:51], v[56:59], v[64:79]
  s_add_u32 m0, s29, 98304
  s_add_u32 s30, s27, 491520
  buffer_load_dwordx4 v9, s[12:15], s30 offen lds
  v_mfma_f32_32x32x16_bf16 v[80:95], v[52:55], v[56:59], v[80:95]
  v_mfma_f32_32x32x16_bf16 v[96:111], v[48:51], v[60:63], v[96:111]
  s_add_u32 m0, s29, 106496
  s_add_u32 s30, s27, 614400
  buffer_load_dwordx4 v9, s[12:15], s30 offen lds
  v_mfma_f32_32x32x16_bf16 v[112:127], v[52:55], v[60:63], v[112:127]
  s_waitcnt lgkmcnt(0)
  ds_read_b128 v[48:51], v13 offset:0
  ds_read_b128 v[52:55], v13 offset:4096
  ds_read_b64_tr_b16 v[56:57], v22 offset:12288
  ds_read_b64_tr_b16 v[58:59], v22 offset:13312
  ds_read_b64_tr_b16 v[60:61], v23 offset:12288
  ds_read_b64_tr_b16 v[62:63], v23 offset:13312
  v_mfma_f32_32x32x16_bf16 v[64:79], v[32:35], v[40:43], v[64:79]
  v_mfma_f32_32x32x16_bf16 v[80:95], v[36:39], v[40:43], v[80:95]
  v_mfma_f32_32x32x16_bf16 v[96:111], v[32:35], v[44:47], v[96:111]
  v_mfma_f32_32x32x16_bf16 v[112:127], v[36:39], v[44:47], v[112:127]
  s_waitcnt vmcnt(6) lgkmcnt(0)
  s_barrier
  ds_read_b128 v[32:35], v14 offset:0
  ds_read_b128 v[36:39], v14 offset:4096
  ds_read_b64_tr_b16 v[40:41], v24 offset:0
  ds_read_b64_tr_b16 v[42:43], v24 offset:1024
  ds_read_b64_tr_b16 v[44:45], v25 offset:0
  ds_read_b64_tr_b16 v[46:47], v25 offset:1024
  v_mfma_f32_32x32x16_bf16 v[64:79], v[48:51], v[56:59], v[64:79]
  s_add_u32 m0, s28, 0
  s_add_u32 s30, s26, 384
  buffer_load_dwordx4 v8, s[8:11], s30 offen lds
  v_mfma_f32_32x32x16_bf16 v[80:95], v[52:55], v[56:59], v[80:95]
  v_mfma_f32_32x32x16_bf16 v[96:111], v[48:51], v[60:63], v[96:111]
  s_add_u32 m0, s28, 8192
  s_add_u32 s30, s26, 82304
  buffer_load_dwordx4 v8, s[8:11], s30 offen lds
  v_mfma_f32_32x32x16_bf16 v[112:127], v[52:55], v[60:63], v[112:127]
  s_waitcnt lgkmcnt(0)
  ds_read_b128 v[48:51], v15 offset:0
  ds_read_b128 v[52:55], v15 offset:4096
  ds_read_b64_tr_b16 v[56:57], v24 offset:4096
  ds_read_b64_tr_b16 v[58:59], v24 offset:5120
  ds_read_b64_tr_b16 v[60:61], v25 offset:4096
  ds_read_b64_tr_b16 v[62:63], v25 offset:5120
  v_mfma_f32_32x32x16_bf16 v[64:79], v[32:35], v[40:43], v[64:79]
  s_add_u32 m0, s28, 16384
  s_add_u32 s30, s26, 164224
  buffer_load_dwordx4 v8, s[8:11], s30 offen lds
  v_mfma_f32_32x32x16_bf16 v[80:95], v[36:39], v[40:43], v[80:95]
  v_mfma_f32_32x32x16_bf16 v[96:111], v[32:35], v[44:47], v[96:111]
  s_add_u32 m0, s28, 24576
  s_add_u32 s30, s26, 246144
  buffer_load_dwordx4 v8, s[8:11], s30 offen lds
  v_mfma_f32_32x32x16_bf16 v[112:127], v[36:39], v[44:47], v[112:127]
  s_waitcnt lgkmcnt(0)
  ds_read_b128 v[32:35], v16 offset:0
  ds_read_b128 v[36:39], v16 offset:4096
  ds_read_b64_tr_b16 v[40:41], v24 offset:8192
  ds_read_b64_tr_b16 v[42:43], v24 offset:9216
  ds_read_b64_tr_b16 v[44:45], v25 offset:8192
  ds_read_b64_tr_b16 v[46:47], v25 offset:9216
  v_mfma_f32_32x32x16_bf16 v[64:79], v[48:51], v[56:59], v[64:79]
  s_add_u32 m0, s29, 0
  s_add_u32 s30, s27, 737280
  buffer_load_dwordx4 v9, s[12:15], s30 offen lds
  v_mfma_f32_32x32x16_bf16 v[80:95], v[52:55], v[56:59], v[80:95]
  v_mfma_f32_32x32x16_bf16 v[96:111], v[48:51], v[60:63], v[96:111]
  s_add_u32 m0, s29, 8192
  s_add_u32 s30, s27, 860160
  buffer_load_dwordx4 v9, s[12:15], s30 offen lds
  v_mfma_f32_32x32x16_bf16 v[112:127], v[52:55], v[60:63], v[112:127]
  s_waitcnt lgkmcnt(0)
  ds_read_b128 v[48:51], v17 offset:0
  ds_read_b128 v[52:55], v17 offset:4096
  ds_read_b64_tr_b16 v[56:57], v24 offset:12288
  ds_read_b64_tr_b16 v[58:59], v24 offset:13312
  ds_read_b64_tr_b16 v[60:61], v25 offset:12288
  ds_read_b64_tr_b16 v[62:63], v25 offset:13312
  v_mfma_f32_32x32x16_bf16 v[64:79], v[32:35], v[40:43], v[64:79]
  v_mfma_f32_32x32x16_bf16 v[80:95], v[36:39], v[40:43], v[80:95]
  v_mfma_f32_32x32x16_bf16 v[96:111], v[32:35], v[44:47], v[96:111]
  v_mfma_f32_32x32x16_bf16 v[112:127], v[36:39], v[44:47], v[112:127]
  s_waitcnt vmcnt(6) lgkmcnt(0)
  s_barrier
  ds_read_b128 v[32:35], v18 offset:0
  ds_read_b128 v[36:39], v18 offset:4096
  ds_read_b64_tr_b16 v[40:41], v26 offset:0
  ds_read_b64_tr_b16 v[42:43], v26 offset:1024
  ds_read_b64_tr_b16 v[44:45], v27 offset:0
  ds_read_b64_tr_b16 v[46:47], v27 offset:1024
  v_mfma_f32_32x32x16_bf16 v[64:79], v[48:51], v[56:59], v[64:79]
  s_add_u32 m0, s28, 49152
  s_add_u32 s30, s26, 512
  buffer_load_dwordx4 v8, s[8:11], s30 offen lds
  v_mfma_f32_32x32x16_bf16 v[80:95], v[52:55], v[56:59], v[80:95]
  v_mfma_f32_32x32x16_bf16 v[96:111], v[48:51], v[60:63], v[96:111]
  s_add_u32 m0, s28, 57344
  s_add_u32 s30, s26, 82432
  buffer_load_dwordx4 v8, s[8:11], s30 offen lds
  v_mfma_f32_32x32x16_bf16 v[112:127], v[52:55], v[60:63], v[112:127]
  s_waitcnt lgkmcnt(0)
  ds_read_b128 v[48:51], v19 offset:0
  ds_read_b128 v[52:55], v19 offset:4096
  ds_read_b64_tr_b16 v[56:57], v26 offset:4096
  ds_read_b64_tr_b16 v[58:59], v26 offset:5120
  ds_read_b64_tr_b16 v[60:61], v27 offset:4096
  ds_read_b64_tr_b16 v[62:63], v27 offset:5120
  v_mfma_f32_32x32x16_bf16 v[64:79], v[32:35], v[40:43], v[64:79]
  s_add_u32 m0, s28, 65536
  s_add_u32 s30, s26, 164352
  buffer_load_dwordx4 v8, s[8:11], s30 offen lds
  v_mfma_f32_32x32x16_bf16 v[80:95], v[36:39], v[40:43], v[80:95]
  v_mfma_f32_32x32x16_bf16 v[96:111], v[32:35], v[44:47], v[96:111]
  s_add_u32 m0, s28, 73728
  s_add_u32 s30, s26, 246272
  buffer_load_dwordx4 v8, s[8:11], s30 offen lds
  v_mfma_f32_32x32x16_bf16 v[112:127], v[36:39], v[44:47], v[112:127]
  s_waitcnt lgkmcnt(0)
  ds_read_b128 v[32:35], v20 offset:0
  ds_read_b128 v[36:39], v20 offset:4096
  ds_read_b64_tr_b16 v[40:41], v26 offset:8192
  ds_read_b64_tr_b16 v[42:43], v26 offset:9216
  ds_read_b64_tr_b16 v[44:45], v27 offset:8192
  ds_read_b64_tr_b16 v[46:47], v27 offset:9216
  v_mfma_f32_32x32x16_bf16 v[64:79], v[48:51], v[56:59], v[64:79]
  s_add_u32 m0, s29, 49152
  s_add_u32 s30, s27, 983040
  buffer_load_dwordx4 v9, s[12:15], s30 offen lds
  v_mfma_f32_32x32x16_bf16 v[80:95], v[52:55], v[56:59], v[80:95]
  v_mfma_f32_32x32x16_bf16 v[96:111], v[48:51], v[60:63], v[96:111]
  s_add_u32 m0, s29, 57344
  s_add_u32 s30, s27, 1105920
  buffer_load_dwordx4 v9, s[12:15], s30 offen lds
  v_mfma_f32_32x32x16_bf16 v[112:127], v[52:55], v[60:63], v[112:127]
  s_waitcnt lgkmcnt(0)
  ds_read_b128 v[48:51], v21 offset:0
  ds_read_b128 v[52:55], v21 offset:4096
  ds_read_b64_tr_b16 v[56:57], v26 offset:12288
  ds_read_b64_tr_b16 v[58:59], v26 offset:13312
  ds_read_b64_tr_b16 v[60:61], v27 offset:12288
  ds_read_b64_tr_b16 v[62:63], v27 offset:13312
  v_mfma_f32_32x32x16_bf16 v[64:79], v[32:35], v[40:43], v[64:79]
  v_mfma_f32_32x32x16_bf16 v[80:95], v[36:39], v[40:43], v[80:95]
  v_mfma_f32_32x32x16_bf16 v[96:111], v[32:35], v[44:47], v[96:111]
  v_mfma_f32_32x32x16_bf16 v[112:127], v[36:39], v[44:47], v[112:127]
  s_waitcnt vmcnt(6) lgkmcnt(0)
  s_barrier
  ds_read_b128 v[32:35], v10 offset:0
  ds_read_b128 v[36:39], v10 offset:4096
  ds_read_b64_tr_b16 v[40:41], v22 offset:0
  ds_read_b64_tr_b16 v[42:43], v22 offset:1024
  ds_read_b64_tr_b16 v[44:45], v23 offset:0
  ds_read_b64_tr_b16 v[46:47], v23 offset:1024
  v_mfma_f32_32x32x16_bf16 v[64:79], v[48:51], v[56:59], v[64:79]
  s_add_u32 m0, s28, 98304
  s_add_u32 s30, s26, 640
  buffer_load_dwordx4 v8, s[8:11], s30 offen lds
  v_mfma_f32_32x32x16_bf16 v[80:95], v[52:55], v[56:59], v[80:95]
  v_mfma_f32_32x32x16_bf16 v[96:111], v[48:51], v[60:63], v[96:111]
  s_add_u32 m0, s28, 106496
  s_add_u32 s30, s26, 82560
  buffer_load_dwordx4 v8, s[8:11], s30 offen lds
  v_mfma_f32_32x32x16_bf16 v[112:127], v[52:55], v[60:63], v[112:127]
  s_waitcnt lgkmcnt(0)
  ds_read_b128 v[48:51], v11 offset:0
  ds_read_b128 v[52:55], v11 offset:4096
  ds_read_b64_tr_b16 v[56:57], v22 offset:4096
  ds_read_b64_tr_b16 v[58:59], v22 offset:5120
  ds_read_b64_tr_b16 v[60:61], v23 offset:4096
  ds_read_b64_tr_b16 v[62:63], v23 offset:5120
  v_mfma_f32_32x32x16_bf16 v[64:79], v[32:35], v[40:43], v[64:79]
  s_add_u32 m0, s28, 114688
  s_add_u32 s30, s26, 164480
  buffer_load_dwordx4 v8, s[8:11], s30 offen lds
  v_mfma_f32_32x32x16_bf16 v[80:95], v[36:39], v[40:43], v[80:95]
  v_mfma_f32_32x32x16_bf16 v[96:111], v[32:35], v[44:47], v[96:111]
  s_add_u32 m0, s28, 122880
  s_add_u32 s30, s26, 246400
  buffer_load_dwordx4 v8, s[8:11], s30 offen lds
  v_mfma_f32_32x32x16_bf16 v[112:127], v[36:39], v[44:47], v[112:127]
  s_waitcnt lgkmcnt(0)
  ds_read_b128 v[32:35], v12 offset:0
  ds_read_b128 v[36:39], v12 offset:4096
  ds_read_b64_tr_b16 v[40:41], v22 offset:8192
  ds_read_b64_tr_b16 v[42:43], v22 offset:9216
  ds_read_b64_tr_b16 v[44:45], v23 offset:8192
  ds_read_b64_tr_b16 v[46:47], v23 offset:9216
  v_mfma_f32_32x32x16_bf16 v[64:79], v[48:51], v[56:59], v[64:79]
  s_add_u32 m0, s29, 98304
  s_add_u32 s30, s27, 1228800
  buffer_load_dwordx4 v9, s[12:15], s30 offen lds
  v_mfma_f32_32x32x16_bf16 v[80:95], v[52:55], v[56:59], v[80:95]
  v_mfma_f32_32x32x16_bf16 v[96:111], v[48:51], v[60:63], v[96:111]
  s_add_u32 m0, s29, 106496
  s_add_u32 s30, s27, 1351680
  buffer_load_dwordx4 v9, s[12:15], s30 offen lds
  v_mfma_f32_32x32x16_bf16 v[112:127], v[52:55], v[60:63], v[112:127]
  s_waitcnt lgkmcnt(0)
  ds_read_b128 v[48:51], v13 offset:0
  ds_read_b128 v[52:55], v13 offset:4096
  ds_read_b64_tr_b16 v[56:57], v22 offset:12288
  ds_read_b64_tr_b16 v[58:59], v22 offset:13312
  ds_read_b64_tr_b16 v[60:61], v23 offset:12288
  ds_read_b64_tr_b16 v[62:63], v23 offset:13312
  v_mfma_f32_32x32x16_bf16 v[64:79], v[32:35], v[40:43], v[64:79]
  v_mfma_f32_32x32x16_bf16 v[80:95], v[36:39], v[40:43], v[80:95]
  v_mfma_f32_32x32x16_bf16 v[96:111], v[32:35], v[44:47], v[96:111]
  v_mfma_f32_32x32x16_bf16 v[112:127], v[36:39], v[44:47], v[112:127]
  s_waitcnt vmcnt(6) lgkmcnt(0)
  s_barrier
  ds_read_b128 v[32:35], v14 offset:0
  ds_read_b128 v[36:39], v14 offset:4096
  ds_read_b64_tr_b16 v[40:41], v24 offset:0
  ds_read_b64_tr_b16 v[42:43], v24 offset:1024
  ds_read_b64_tr_b16 v[44:45], v25 offset:0
  ds_read_b64_tr_b16 v[46:47], v25 offset:1024
  v_mfma_f32_32x32x16_bf16 v[64:79], v[48:51], v[56:59], v[64:79]
  s_add_u32 m0, s28, 0
  s_add_u32 s30, s26, 768
  buffer_load_dwordx4 v8, s[8:11], s30 offen lds
  v_mfma_f32_32x32x16_bf16 v[80:95], v[52:55], v[56:59], v[80:95]
  v_mfma_f32_32x32x16_bf16 v[96:111], v[48:51], v[60:63], v[96:111]
  s_add_u32 m0, s28, 8192
  s_add_u32 s30, s26, 82688
  buffer_load_dwordx4 v8, s[8:11], s30 offen lds
  v_mfma_f32_32x32x16_bf16 v[112:127], v[52:55], v[60:63], v[112:127]
  s_waitcnt lgkmcnt(0)
  ds_read_b128 v[48:51], v15 offset:0
  ds_read_b128 v[52:55], v15 offset:4096
  ds_read_b64_tr_b16 v[56:57], v24 offset:4096
  ds_read_b64_tr_b16 v[58:59], v24 offset:5120
  ds_read_b64_tr_b16 v[60:61], v25 offset:4096
  ds_read_b64_tr_b16 v[62:63], v25 offset:5120
  v_mfma_f32_32x32x16_bf16 v[64:79], v[32:35], v[40:43], v[64:79]
  s_add_u32 m0, s28, 16384
  s_add_u32 s30, s26, 164608
  buffer_load_dwordx4 v8, s[8:11], s30 offen lds
  v_mfma_f32_32x32x16_bf16 v[80:95], v[36:39], v[40:43], v[80:95]
  v_mfma_f32_32x32x16_bf16 v[96:111], v[32:35], v[44:47], v[96:111]
  s_add_u32 m0, s28, 24576
  s_add_u32 s30, s26, 246528
  buffer_load_dwordx4 v8, s[8:11], s30 offen lds
  v_mfma_f32_32x32x16_bf16 v[112:127], v[36:39], v[44:47], v[112:127]
  s_waitcnt lgkmcnt(0)
  ds_read_b128 v[32:35], v16 offset:0
  ds_read_b128 v[36:39], v16 offset:4096
  ds_read_b64_tr_b16 v[40:41], v24 offset:8192
  ds_read_b64_tr_b16 v[42:43], v24 offset:9216
  ds_read_b64_tr_b16 v[44:45], v25 offset:8192
  ds_read_b64_tr_b16 v[46:47], v25 offset:9216
  v_mfma_f32_32x32x16_bf16 v[64:79], v[48:51], v[56:59], v[64:79]
  s_add_u32 m0, s29, 0
  s_add_u32 s30, s27, 1474560
  buffer_load_dwordx4 v9, s[12:15], s30 offen lds
  v_mfma_f32_32x32x16_bf16 v[80:95], v[52:55], v[56:59], v[80:95]
  v_mfma_f32_32x32x16_bf16 v[96:111], v[48:51], v[60:63], v[96:111]
  s_add_u32 m0, s29, 8192
  s_add_u32 s30, s27, 1597440
  buffer_load_dwordx4 v9, s[12:15], s30 offen lds
  v_mfma_f32_32x32x16_bf16 v[112:127], v[52:55], v[60:63], v[112:127]
  s_waitcnt lgkmcnt(0)
  ds_read_b128 v[48:51], v17 offset:0
  ds_read_b128 v[52:55], v17 offset:4096
  ds_read_b64_tr_b16 v[56:57], v24 offset:12288
  ds_read_b64_tr_b16 v[58:59], v24 offset:13312
  ds_read_b64_tr_b16 v[60:61], v25 offset:12288
  ds_read_b64_tr_b16 v[62:63], v25 offset:13312
  v_mfma_f32_32x32x16_bf16 v[64:79], v[32:35], v[40:43], v[64:79]
  v_mfma_f32_32x32x16_bf16 v[80:95], v[36:39], v[40:43], v[80:95]
  v_mfma_f32_32x32x16_bf16 v[96:111], v[32:35], v[44:47], v[96:111]
  v_mfma_f32_32x32x16_bf16 v[112:127], v[36:39], v[44:47], v[112:127]
  s_waitcnt vmcnt(6) lgkmcnt(0)
  s_barrier
  ds_read_b128 v[32:35], v18 offset:0
  ds_read_b128 v[36:39], v18 offset:4096
  ds_read_b64_tr_b16 v[40:41], v26 offset:0
  ds_read_b64_tr_b16 v[42:43], v26 offset:1024
  ds_read_b64_tr_b16 v[44:45], v27 offset:0
  ds_read_b64_tr_b16 v[46:47], v27 offset:1024
  v_mfma_f32_32x32x16_bf16 v[64:79], v[48:51], v[56:59], v[64:79]
  s_add_u32 m0, s28, 49152
  s_add_u32 s30, s26, 896
  buffer_load_dwordx4 v8, s[8:11], s30 offen lds
  v_mfma_f32_32x32x16_bf16 v[80:95], v[52:55], v[56:59], v[80:95]
  v_mfma_f32_32x32x16_bf16 v[96:111], v[48:51], v[60:63], v[96:111]
  s_add_u32 m0, s28, 57344
  s_add_u32 s30, s26, 82816
  buffer_load_dwordx4 v8, s[8:11], s30 offen lds
  v_mfma_f32_32x32x16_bf16 v[112:127], v[52:55], v[60:63], v[112:127]
  s_waitcnt lgkmcnt(0)
  ds_read_b128 v[48:51], v19 offset:0
  ds_read_b128 v[52:55], v19 offset:4096
  ds_read_b64_tr_b16 v[56:57], v26 offset:4096
  ds_read_b64_tr_b16 v[58:59], v26 offset:5120
  ds_read_b64_tr_b16 v[60:61], v27 offset:4096
  ds_read_b64_tr_b16 v[62:63], v27 offset:5120
  v_mfma_f32_32x32x16_bf16 v[64:79], v[32:35], v[40:43], v[64:79]
  s_add_u32 m0, s28, 65536
  s_add_u32 s30, s26, 164736
  buffer_load_dwordx4 v8, s[8:11], s30 offen lds
  v_mfma_f32_32x32x16_bf16 v[80:95], v[36:39], v[40:43], v[80:95]
  v_mfma_f32_32x32x16_bf16 v[96:111], v[32:35], v[44:47], v[96:111]
  s_add_u32 m0, s28, 73728
  s_add_u32 s30, s26, 246656
  buffer_load_dwordx4 v8, s[8:11], s30 offen lds
  v_mfma_f32_32x32x16_bf16 v[112:127], v[36:39], v[44:47], v[112:127]
  s_waitcnt lgkmcnt(0)
  ds_read_b128 v[32:35], v20 offset:0
  ds_read_b128 v[36:39], v20 offset:4096
  ds_read_b64_tr_b16 v[40:41], v26 offset:8192
  ds_read_b64_tr_b16 v[42:43], v26 offset:9216
  ds_read_b64_tr_b16 v[44:45], v27 offset:8192
  ds_read_b64_tr_b16 v[46:47], v27 offset:9216
  v_mfma_f32_32x32x16_bf16 v[64:79], v[48:51], v[56:59], v[64:79]
  s_add_u32 m0, s29, 49152
  s_add_u32 s30, s27, 1720320
  buffer_load_dwordx4 v9, s[12:15], s30 offen lds
  v_mfma_f32_32x32x16_bf16 v[80:95], v[52:55], v[56:59], v[80:95]
  v_mfma_f32_32x32x16_bf16 v[96:111], v[48:51], v[60:63], v[96:111]
  s_add_u32 m0, s29, 57344
  s_add_u32 s30, s27, 1843200
  buffer_load_dwordx4 v9, s[12:15], s30 offen lds
  v_mfma_f32_32x32x16_bf16 v[112:127], v[52:55], v[60:63], v[112:127]
  s_waitcnt lgkmcnt(0)
  ds_read_b128 v[48:51], v21 offset:0
  ds_read_b128 v[52:55], v21 offset:4096
  ds_read_b64_tr_b16 v[56:57], v26 offset:12288
  ds_read_b64_tr_b16 v[58:59], v26 offset:13312
  ds_read_b64_tr_b16 v[60:61], v27 offset:12288
  ds_read_b64_tr_b16 v[62:63], v27 offset:13312
  v_mfma_f32_32x32x16_bf16 v[64:79], v[32:35], v[40:43], v[64:79]
  v_mfma_f32_32x32x16_bf16 v[80:95], v[36:39], v[40:43], v[80:95]
  v_mfma_f32_32x32x16_bf16 v[96:111], v[32:35], v[44:47], v[96:111]
  v_mfma_f32_32x32x16_bf16 v[112:127], v[36:39], v[44:47], v[112:127]
  s_waitcnt vmcnt(6) lgkmcnt(0)
  s_barrier
  ds_read_b128 v[32:35], v10 offset:0
  ds_read_b128 v[36:39], v10 offset:4096
  ds_read_b64_tr_b16 v[40:41], v22 offset:0
  ds_read_b64_tr_b16 v[42:43], v22 offset:1024
  ds_read_b64_tr_b16 v[44:45], v23 offset:0
  ds_read_b64_tr_b16 v[46:47], v23 offset:1024
  v_mfma_f32_32x32x16_bf16 v[64:79], v[48:51], v[56:59], v[64:79]
  s_add_u32 m0, s28, 98304
  s_add_u32 s30, s26, 1024
  buffer_load_dwordx4 v8, s[8:11], s30 offen lds
  v_mfma_f32_32x32x16_bf16 v[80:95], v[52:55], v[56:59], v[80:95]
  v_mfma_f32_32x32x16_bf16 v[96:111], v[48:51], v[60:63], v[96:111]
  s_add_u32 m0, s28, 106496
  s_add_u32 s30, s26, 82944
  buffer_load_dwordx4 v8, s[8:11], s30 offen lds
  v_mfma_f32_32x32x16_bf16 v[112:127], v[52:55], v[60:63], v[112:127]
  s_waitcnt lgkmcnt(0)
  ds_read_b128 v[48:51], v11 offset:0
  ds_read_b128 v[52:55], v11 offset:4096
  ds_read_b64_tr_b16 v[56:57], v22 offset:4096
  ds_read_b64_tr_b16 v[58:59], v22 offset:5120
  ds_read_b64_tr_b16 v[60:61], v23 offset:4096
  ds_read_b64_tr_b16 v[62:63], v23 offset:5120
  v_mfma_f32_32x32x16_bf16 v[64:79], v[32:35], v[40:43], v[64:79]
  s_add_u32 m0, s28, 114688
  s_add_u32 s30, s26, 164864
  buffer_load_dwordx4 v8, s[8:11], s30 offen lds
  v_mfma_f32_32x32x16_bf16 v[80:95], v[36:39], v[40:43], v[80:95]
  v_mfma_f32_32x32x16_bf16 v[96:111], v[32:35], v[44:47], v[96:111]
  s_add_u32 m0, s28, 122880
  s_add_u32 s30, s26, 246784
  buffer_load_dwordx4 v8, s[8:11], s30 offen lds
  v_mfma_f32_32x32x16_bf16 v[112:127], v[36:39], v[44:47], v[112:127]
  s_waitcnt lgkmcnt(0)
  ds_read_b128 v[32:35], v12 offset:0
  ds_read_b128 v[36:39], v12 offset:4096
  ds_read_b64_tr_b16 v[40:41], v22 offset:8192
  ds_read_b64_tr_b16 v[42:43], v22 offset:9216
  ds_read_b64_tr_b16 v[44:45], v23 offset:8192
  ds_read_b64_tr_b16 v[46:47], v23 offset:9216
  v_mfma_f32_32x32x16_bf16 v[64:79], v[48:51], v[56:59], v[64:79]
  s_add_u32 m0, s29, 98304
  s_add_u32 s30, s27, 1966080
  buffer_load_dwordx4 v9, s[12:15], s30 offen lds
  v_mfma_f32_32x32x16_bf16 v[80:95], v[52:55], v[56:59], v[80:95]
  v_mfma_f32_32x32x16_bf16 v[96:111], v[48:51], v[60:63], v[96:111]
  s_add_u32 m0, s29, 106496
  s_add_u32 s30, s27, 2088960
  buffer_load_dwordx4 v9, s[12:15], s30 offen lds
  v_mfma_f32_32x32x16_bf16 v[112:127], v[52:55], v[60:63], v[112:127]
  s_waitcnt lgkmcnt(0)
  ds_read_b128 v[48:51], v13 offset:0
  ds_read_b128 v[52:55], v13 offset:4096
  ds_read_b64_tr_b16 v[56:57], v22 offset:12288
  ds_read_b64_tr_b16 v[58:59], v22 offset:13312
  ds_read_b64_tr_b16 v[60:61], v23 offset:12288
  ds_read_b64_tr_b16 v[62:63], v23 offset:13312
  v_mfma_f32_32x32x16_bf16 v[64:79], v[32:35], v[40:43], v[64:79]
  v_mfma_f32_32x32x16_bf16 v[80:95], v[36:39], v[40:43], v[80:95]
  v_mfma_f32_32x32x16_bf16 v[96:111], v[32:35], v[44:47], v[96:111]
  v_mfma_f32_32x32x16_bf16 v[112:127], v[36:39], v[44:47], v[112:127]
  s_waitcnt vmcnt(6) lgkmcnt(0)
  s_barrier
  ds_read_b128 v[32:35], v14 offset:0
  ds_read_b128 v[36:39], v14 offset:4096
  ds_read_b64_tr_b16 v[40:41], v24 offset:0
  ds_read_b64_tr_b16 v[42:43], v24 offset:1024
  ds_read_b64_tr_b16 v[44:45], v25 offset:0
  ds_read_b64_tr_b16 v[46:47], v25 offset:1024
  v_mfma_f32_32x32x16_bf16 v[64:79], v[48:51], v[56:59], v[64:79]
  s_add_u32 m0, s28, 0
  s_add_u32 s30, s26, 1152
  buffer_load_dwordx4 v8, s[8:11], s30 offen lds
  v_mfma_f32_32x32x16_bf16 v[80:95], v[52:55], v[56:59], v[80:95]
  v_mfma_f32_32x32x16_bf16 v[96:111], v[48:51], v[60:63], v[96:111]
  s_add_u32 m0, s28, 8192
  s_add_u32 s30, s26, 83072
  buffer_load_dwordx4 v8, s[8:11], s30 offen lds
  v_mfma_f32_32x32x16_bf16 v[112:127], v[52:55], v[60:63], v[112:127]
  s_waitcnt lgkmcnt(0)
  ds_read_b128 v[48:51], v15 offset:0
  ds_read_b128 v[52:55], v15 offset:4096
  ds_read_b64_tr_b16 v[56:57], v24 offset:4096
  ds_read_b64_tr_b16 v[58:59], v24 offset:5120
  ds_read_b64_tr_b16 v[60:61], v25 offset:4096
  ds_read_b64_tr_b16 v[62:63], v25 offset:5120
  v_mfma_f32_32x32x16_bf16 v[64:79], v[32:35], v[40:43], v[64:79]
  s_add_u32 m0, s28, 16384
  s_add_u32 s30, s26, 164992
  buffer_load_dwordx4 v8, s[8:11], s30 offen lds
  v_mfma_f32_32x32x16_bf16 v[80:95], v[36:39], v[40:43], v[80:95]
  v_mfma_f32_32x32x16_bf16 v[96:111], v[32:35], v[44:47], v[96:111]
  s_add_u32 m0, s28, 24576
  s_add_u32 s30, s26, 246912
  buffer_load_dwordx4 v8, s[8:11], s30 offen lds
  v_mfma_f32_32x32x16_bf16 v[112:127], v[36:39], v[44:47], v[112:127]
  s_waitcnt lgkmcnt(0)
  ds_read_b128 v[32:35], v16 offset:0
  ds_read_b128 v[36:39], v16 offset:4096
  ds_read_b64_tr_b16 v[40:41], v24 offset:8192
  ds_read_b64_tr_b16 v[42:43], v24 offset:9216
  ds_read_b64_tr_b16 v[44:45], v25 offset:8192
  ds_read_b64_tr_b16 v[46:47], v25 offset:9216
  v_mfma_f32_32x32x16_bf16 v[64:79], v[48:51], v[56:59], v[64:79]
  s_add_u32 m0, s29, 0
  s_add_u32 s30, s27, 2211840
  buffer_load_dwordx4 v9, s[12:15], s30 offen lds
  v_mfma_f32_32x32x16_bf16 v[80:95], v[52:55], v[56:59], v[80:95]
  v_mfma_f32_32x32x16_bf16 v[96:111], v[48:51], v[60:63], v[96:111]
  s_add_u32 m0, s29, 8192
  s_add_u32 s30, s27, 2334720
  buffer_load_dwordx4 v9, s[12:15], s30 offen lds
  v_mfma_f32_32x32x16_bf16 v[112:127], v[52:55], v[60:63], v[112:127]
  s_waitcnt lgkmcnt(0)
  ds_read_b128 v[48:51], v17 offset:0
  ds_read_b128 v[52:55], v17 offset:4096
  ds_read_b64_tr_b16 v[56:57], v24 offset:12288
  ds_read_b64_tr_b16 v[58:59], v24 offset:13312
  ds_read_b64_tr_b16 v[60:61], v25 offset:12288
  ds_read_b64_tr_b16 v[62:63], v25 offset:13312
  v_mfma_f32_32x32x16_bf16 v[64:79], v[32:35], v[40:43], v[64:79]
  v_mfma_f32_32x32x16_bf16 v[80:95], v[36:39], v[40:43], v[80:95]
  v_mfma_f32_32x32x16_bf16 v[96:111], v[32:35], v[44:47], v[96:111]
  v_mfma_f32_32x32x16_bf16 v[112:127], v[36:39], v[44:47], v[112:127]
  s_waitcnt vmcnt(6) lgkmcnt(0)
  s_barrier
  ds_read_b128 v[32:35], v18 offset:0
  ds_read_b128 v[36:39], v18 offset:4096
  ds_read_b64_tr_b16 v[40:41], v26 offset:0
  ds_read_b64_tr_b16 v[42:43], v26 offset:1024
  ds_read_b64_tr_b16 v[44:45], v27 offset:0
  ds_read_b64_tr_b16 v[46:47], v27 offset:1024
  v_mfma_f32_32x32x16_bf16 v[64:79], v[48:51], v[56:59], v[64:79]
  v_mfma_f32_32x32x16_bf16 v[80:95], v[52:55], v[56:59], v[80:95]
  v_mfma_f32_32x32x16_bf16 v[96:111], v[48:51], v[60:63], v[96:111]
  v_mfma_f32_32x32x16_bf16 v[112:127], v[52:55], v[60:63], v[112:127]
  s_waitcnt lgkmcnt(0)
  ds_read_b128 v[48:51], v19 offset:0
  ds_read_b128 v[52:55], v19 offset:4096
  ds_read_b64_tr_b16 v[56:57], v26 offset:4096
  ds_read_b64_tr_b16 v[58:59], v26 offset:5120
  ds_read_b64_tr_b16 v[60:61], v27 offset:4096
  ds_read_b64_tr_b16 v[62:63], v27 offset:5120
  v_mfma_f32_32x32x16_bf16 v[64:79], v[32:35], v[40:43], v[64:79]
  v_mfma_f32_32x32x16_bf16 v[80:95], v[36:39], v[40:43], v[80:95]
  v_mfma_f32_32x32x16_bf16 v[96:111], v[32:35], v[44:47], v[96:111]
  v_mfma_f32_32x32x16_bf16 v[112:127], v[36:39], v[44:47], v[112:127]
  s_waitcnt lgkmcnt(0)
  ds_read_b128 v[32:35], v20 offset:0
  ds_read_b128 v[36:39], v20 offset:4096
  ds_read_b64_tr_b16 v[40:41], v26 offset:8192
  ds_read_b64_tr_b16 v[42:43], v26 offset:9216
  ds_read_b64_tr_b16 v[44:45], v27 offset:8192
  ds_read_b64_tr_b16 v[46:47], v27 offset:9216
  v_mfma_f32_32x32x16_bf16 v[64:79], v[48:51], v[56:59], v[64:79]
  v_mfma_f32_32x32x16_bf16 v[80:95], v[52:55], v[56:59], v[80:95]
  v_mfma_f32_32x32x16_bf16 v[96:111], v[48:51], v[60:63], v[96:111]
  v_mfma_f32_32x32x16_bf16 v[112:127], v[52:55], v[60:63], v[112:127]
  s_waitcnt lgkmcnt(0)
  ds_read_b128 v[48:51], v21 offset:0
  ds_read_b128 v[52:55], v21 offset:4096
  ds_read_b64_tr_b16 v[56:57], v26 offset:12288
  ds_read_b64_tr_b16 v[58:59], v26 offset:13312
  ds_read_b64_tr_b16 v[60:61], v27 offset:12288
  ds_read_b64_tr_b16 v[62:63], v27 offset:13312
  v_mfma_f32_32x32x16_bf16 v[64:79], v[32:35], v[40:43], v[64:79]
  v_mfma_f32_32x32x16_bf16 v[80:95], v[36:39], v[40:43], v[80:95]
  v_mfma_f32_32x32x16_bf16 v[96:111], v[32:35], v[44:47], v[96:111]
  v_mfma_f32_32x32x16_bf16 v[112:127], v[36:39], v[44:47], v[112:127]
  s_waitcnt vmcnt(0) lgkmcnt(0)
  s_barrier
  ds_read_b128 v[32:35], v10 offset:0
  ds_read_b128 v[36:39], v10 offset:4096
  ds_read_b64_tr_b16 v[40:41], v22 offset:0
  ds_read_b64_tr_b16 v[42:43], v22 offset:1024
  ds_read_b64_tr_b16 v[44:45], v23 offset:0
  ds_read_b64_tr_b16 v[46:47], v23 offset:1024
  v_mfma_f32_32x32x16_bf16 v[64:79], v[48:51], v[56:59], v[64:79]
  v_mfma_f32_32x32x16_bf16 v[80:95], v[52:55], v[56:59], v[80:95]
  v_mfma_f32_32x32x16_bf16 v[96:111], v[48:51], v[60:63], v[96:111]
  v_mfma_f32_32x32x16_bf16 v[112:127], v[52:55], v[60:63], v[112:127]
  s_waitcnt lgkmcnt(0)
  ds_read_b128 v[48:51], v11 offset:0
  ds_read_b128 v[52:55], v11 offset:4096
  ds_read_b64_tr_b16 v[56:57], v22 offset:4096
  ds_read_b64_tr_b16 v[58:59], v22 offset:5120
  ds_read_b64_tr_b16 v[60:61], v23 offset:4096
  ds_read_b64_tr_b16 v[62:63], v23 offset:5120
  v_mfma_f32_32x32x16_bf16 v[64:79], v[32:35], v[40:43], v[64:79]
  v_mfma_f32_32x32x16_bf16 v[80:95], v[36:39], v[40:43], v[80:95]
  v_mfma_f32_32x32x16_bf16 v[96:111], v[32:35], v[44:47], v[96:111]
  v_mfma_f32_32x32x16_bf16 v[112:127], v[36:39], v[44:47], v[112:127]
  s_waitcnt lgkmcnt(0)
  ds_read_b128 v[32:35], v12 offset:0
  ds_read_b128 v[36:39], v12 offset:4096
  ds_read_b64_tr_b16 v[40:41], v22 offset:8192
  ds_read_b64_tr_b16 v[42:43], v22 offset:9216
  ds_read_b64_tr_b16 v[44:45], v23 offset:8192
  ds_read_b64_tr_b16 v[46:47], v23 offset:9216
  v_mfma_f32_32x32x16_bf16 v[64:79], v[48:51], v[56:59], v[64:79]
  v_mfma_f32_32x32x16_bf16 v[80:95], v[52:55], v[56:59], v[80:95]
  v_mfma_f32_32x32x16_bf16 v[96:111], v[48:51], v[60:63], v[96:111]
  v_mfma_f32_32x32x16_bf16 v[112:127], v[52:55], v[60:63], v[112:127]
  s_waitcnt lgkmcnt(0)
  ds_read_b128 v[48:51], v13 offset:0
  ds_read_b128 v[52:55], v13 offset:4096
  ds_read_b64_tr_b16 v[56:57], v22 offset:12288
  ds_read_b64_tr_b16 v[58:59], v22 offset:13312
  ds_read_b64_tr_b16 v[60:61], v23 offset:12288
  ds_read_b64_tr_b16 v[62:63], v23 offset:13312
  v_mfma_f32_32x32x16_bf16 v[64:79], v[32:35], v[40:43], v[64:79]
  v_mfma_f32_32x32x16_bf16 v[80:95], v[36:39], v[40:43], v[80:95]
  v_mfma_f32_32x32x16_bf16 v[96:111], v[32:35], v[44:47], v[96:111]
  v_mfma_f32_32x32x16_bf16 v[112:127], v[36:39], v[44:47], v[112:127]
  s_waitcnt lgkmcnt(0)
  v_mfma_f32_32x32x16_bf16 v[64:79], v[48:51], v[56:59], v[64:79]
  v_mfma_f32_32x32x16_bf16 v[80:95], v[52:55], v[56:59], v[80:95]
  v_mfma_f32_32x32x16_bf16 v[96:111], v[48:51], v[60:63], v[96:111]
  v_mfma_f32_32x32x16_bf16 v[112:127], v[52:55], v[60:63], v[112:127]
  s_lshr_b32 s3, s25, 2
  s_lshl_b32 s3, s3, 6
  s_lshl_b32 s30, s24, 7
  s_add_u32 s3, s3, s30
  s_and_b32 s31, s25, 3
  s_lshl_b32 s31, s31, 1
  s_lshl_b32 s30, s21, 3
  s_add_u32 s31, s31, s30
  v_add_u32 v4, s3, v2
  v_add_u32 v4, 0, v4
  v_mul_u32_u24 v28, 3277, v4
  v_lshrrev_b32 v28, 16, v28
  v_mul_u32_u24 v5, 20, v28
  v_sub_u32 v29, v4, v5
  v_and_b32 v5, 1, v28
  v_lshlrev_b32 v5, 2, v5
  v_sub_u32 v29, v29, v5
  v_add_u32 v5, 20, v29
  v_cmp_gt_i32 vcc, 0, v29
  s_nop 1
  v_cndmask_b32 v29, v29, v5, vcc
  v_add_u32 v4, s3, v2
  v_add_u32 v4, 32, v4
  v_mul_u32_u24 v30, 3277, v4
  v_lshrrev_b32 v30, 16, v30
  v_mul_u32_u24 v5, 20, v30
  v_sub_u32 v31, v4, v5
  v_and_b32 v5, 1, v30
  v_lshlrev_b32 v5, 2, v5
  v_sub_u32 v31, v31, v5
  v_add_u32 v5, 20, v31
  v_cmp_gt_i32 vcc, 0, v31
  s_nop 1
  v_cndmask_b32 v31, v31, v5, vcc
  s_cmp_eq_u32 s20, 0
  s_cbranch_scc0 L_qkv_kernel_epiVB
  v_and_b32 v4, 0x13, v29
  v_and_b32 v5, 4, v29
  v_lshl_or_b32 v4, v5, 1, v4
  v_and_b32 v5, 8, v29
  v_lshrrev_b32 v5, 1, v5
  v_or_b32 v4, v4, v5
  v_mul_u32_u24 v28, 81920, v28
  v_lshl_add_u32 v28, v4, 4, v28
  v_mul_u32_u24 v5, 320, v3
  v_add_u32 v28, v28, v5
  v_add_u32 v29, 640, v28
  v_and_b32 v4, 0x13, v31
  v_and_b32 v5, 4, v31
  v_lshl_or_b32 v4, v5, 1, v4
  v_and_b32 v5, 8, v31
  v_lshrrev_b32 v5, 1, v5
  v_or_b32 v4, v4, v5
  v_mul_u32_u24 v30, 81920, v30
  v_lshl_add_u32 v30, v4, 4, v30
  v_mul_u32_u24 v5, 320, v3
  v_add_u32 v30, v30, v5
  v_add_u32 v31, 640, v30
  s_mul_i32 s26, s31, 1280
  s_add_u32 s26, s26, 5242880
  s_add_u32 s27, s26, 1280
  s_branch L_qkv_kernel_epiV
L_qkv_kernel_epiVB:
  v_lshrrev_b32 v4, 3, v29
  v_lshlrev_b32 v4, 2, v4
  v_bfe_u32 v5, v29, 2, 1
  v_mul_u32_u24 v5, 12, v5
  v_add_u32 v4, v4, v5
  v_and_b32 v5, 3, v29
  v_add_u32 v4, v4, v5
  v_mul_u32_u24 v28, 81920, v28
  v_lshl_add_u32 v28, v4, 4, v28
  v_mul_u32_u24 v5, 40960, v3
  v_add_u32 v28, v28, v5
  v_add_u32 v29, 320, v28
  v_lshrrev_b32 v4, 3, v31
  v_lshlrev_b32 v4, 2, v4
  v_bfe_u32 v5, v31, 2, 1
  v_mul_u32_u24 v5, 12, v5
  v_add_u32 v4, v4, v5
  v_and_b32 v5, 3, v31
  v_add_u32 v4, v4, v5
  v_mul_u32_u24 v30, 81920, v30
  v_lshl_add_u32 v30, v4, 4, v30
  v_mul_u32_u24 v5, 40960, v3
  v_add_u32 v30, v30, v5
  v_add_u32 v31, 320, v30
  s_mul_i32 s26, s31, 640
  s_add_u32 s26, s26, 13107200
  s_add_u32 s27, s26, 640
L_qkv_kernel_epiV:
  s_mov_b32 s30, 1.0
  s_nop 7
  v_cvt_pk_bf16_f32 v64, v64, v65
  v_cvt_pk_bf16_f32 v65, v66, v67
  v_cvt_pk_bf16_f32 v66, v68, v69
  v_cvt_pk_bf16_f32 v67, v70, v71
  buffer_store_dwordx4 v[64:67], v28, s[16:19], s26 offen sc1
  v_cvt_pk_bf16_f32 v72, v72, v73
  v_cvt_pk_bf16_f32 v73, v74, v75
  v_cvt_pk_bf16_f32 v74, v76, v77
  v_cvt_pk_bf16_f32 v75, v78, v79
  buffer_store_dwordx4 v[72:75], v29, s[16:19], s26 offen sc1
  v_cvt_pk_bf16_f32 v96, v96, v97
  v_cvt_pk_bf16_f32 v97, v98, v99
  v_cvt_pk_bf16_f32 v98, v100, v101
  v_cvt_pk_bf16_f32 v99, v102, v103
  buffer_store_dwordx4 v[96:99], v30, s[16:19], s26 offen sc1
  v_cvt_pk_bf16_f32 v104, v104, v105
  v_cvt_pk_bf16_f32 v105, v106, v107
  v_cvt_pk_bf16_f32 v106, v108, v109
  v_cvt_pk_bf16_f32 v107, v110, v111
  buffer_store_dwordx4 v[104:107], v31, s[16:19], s26 offen sc1
  v_cvt_pk_bf16_f32 v80, v80, v81
  v_cvt_pk_bf16_f32 v81, v82, v83
  v_cvt_pk_bf16_f32 v82, v84, v85
  v_cvt_pk_bf16_f32 v83, v86, v87
  buffer_store_dwordx4 v[80:83], v28, s[16:19], s27 offen sc1
  v_cvt_pk_bf16_f32 v88, v88, v89
  v_cvt_pk_bf16_f32 v89, v90, v91
  v_cvt_pk_bf16_f32 v90, v92, v93
  v_cvt_pk_bf16_f32 v91, v94, v95
  buffer_store_dwordx4 v[88:91], v29, s[16:19], s27 offen sc1
  v_cvt_pk_bf16_f32 v112, v112, v113
  v_cvt_pk_bf16_f32 v113, v114, v115
  v_cvt_pk_bf16_f32 v114, v116, v117
  v_cvt_pk_bf16_f32 v115, v118, v119
  buffer_store_dwordx4 v[112:115], v30, s[16:19], s27 offen sc1
  v_cvt_pk_bf16_f32 v120, v120, v121
  v_cvt_pk_bf16_f32 v121, v122, v123
  v_cvt_pk_bf16_f32 v122, v124, v125
  v_cvt_pk_bf16_f32 v123, v126, v127
  buffer_store_dwordx4 v[120:123], v31, s[16:19], s27 offen sc1
L_qkv_kernel_end:
  s_cmp_lg_u32 s2, 0
  s_cbranch_scc1 L_qkv_kernel_na
  s_add_u32 s36, s36, 20975616
  s_addc_u32 s37, s37, 0
  s_load_dword s3, s[36:37], 0
  v_cmp_eq_u32 vcc, 0, v0
  v_mov_b32 v3, 0
  s_waitcnt lgkmcnt(0)
  s_mul_i32 s3, s3, 0x9e3779b1
  s_add_u32 s3, s3, 0x7f4a7c15
  v_mov_b32 v2, s3
  s_and_saveexec_b64 s[38:39], vcc
  global_store_dword v3, v2, s[36:37]
  s_mov_b64 exec, s[38:39]
  s_sub_u32 s36, s36, 20975616
  s_subb_u32 s37, s37, 0
L_qkv_kernel_na:
L_qkv_kernel_exit:
  s_endpgm
.section .rodata,"a"
.p2align 6
.amdhsa_kernel qkv_kernel
  .amdhsa_next_free_vgpr 128
  .amdhsa_next_free_sgpr 100
  .amdhsa_accum_offset 128
  .amdhsa_group_segment_fixed_size 0
  .amdhsa_kernarg_size 72
  .amdhsa_user_sgpr_count 2
  .amdhsa_user_sgpr_kernarg_segment_ptr 1
  .amdhsa_system_sgpr_workgroup_id_x 1
.end_amdhsa_kernel
.text
.globl tail_kernel
.p2align 8
.type tail_kernel,@function
tail_kernel:
  s_cmp_ge_u32 s2, 256
  s_cbranch_scc1 L_tail_kernel_exit
  s_load_dwordx2 s[4:5], s[0:1], 64
  s_load_dwordx2 s[48:49], s[0:1], 16
  s_load_dwordx2 s[50:51], s[0:1], 40
  s_and_b32 s26, s2, 7
  s_lshl_b32 s26, s26, 2
  s_bfe_u32 s27, s2, 0x20003
  s_add_u32 s20, s26, s27
  s_lshr_b32 s21, s2, 5
  s_and_b32 s23, s20, 1
  v_and_b32 v1, 63, v0
  v_lshrrev_b32 v4, 6, v0
  v_and_b32 v2, 31, v1
  v_readfirstlane_b32 s22, v4
  v_lshrrev_b32 v3, 5, v1
  s_mov_b32 s30, 0x000fffff
  s_mov_b32 s31, 0x000fffff
  s_mov_b32 s32, -1
  s_mov_b32 s33, 0
  s_lshr_b32 s26, s20, 1
  s_mul_i32 s26, s26, 163840
  s_mul_i32 s27, s23, 1536
  v_lshlrev_b32 v4, 4, v1
  v_add_u32 v4, s27, v4
  v_add_u32 v8, s26, v4
  s_lshl_b32 s27, s23, 3
  s_add_u32 s27, s27, 1024
  v_lshlrev_b32 v4, 4, v2
  v_add_u32 v4, s27, v4
  v_add_u32 v9, s26, v4
  s_mul_i32 s26, s20, 81920
  v_mul_u32_u24 v4, 320, v3
  v_lshl_add_u32 v4, v2, 4, v4
  v_add_u32 v10, s26, v4
  s_and_b32 s26, s22, 3
  s_mul_i32 s24, s26, 40960
  s_add_u32 s24, s24, 2621440
  s_mul_i32 s25, s26, 20480
  s_add_u32 s25, s25, 5242880
  s_lshr_b32 s26, s22, 2
  s_lshl_b32 s26, s26, 2
  s_lshl_b32 s27, s21, 3
  s_add_u32 s40, s26, s27
  s_mul_i32 s41, s40, 2560
  s_waitcnt lgkmcnt(0)
  s_mov_b32 s8, s4
  s_and_b32 s9, s5, 0xffff
  s_mov_b32 s10, 20971520
  s_mov_b32 s11, 0x20000
  s_add_u32 s26, s41, 0
  buffer_load_dwordx4 v[12:15], v8, s[8:11], s26 offen sc1
  buffer_load_dwordx2 v[16:17], v9, s[8:11], s26 offen sc1
  s_add_u32 s26, s41, 2560
  buffer_load_dwordx4 v[20:23], v8, s[8:11], s26 offen sc1
  buffer_load_dwordx2 v[24:25], v9, s[8:11], s26 offen sc1
  s_add_u32 s26, s41, 5120
  buffer_load_dwordx4 v[28:31], v8, s[8:11], s26 offen sc1
  buffer_load_dwordx2 v[32:33], v9, s[8:11], s26 offen sc1
  s_add_u32 s26, s41, 7680
  buffer_load_dwordx4 v[36:39], v8, s[8:11], s26 offen sc1
  buffer_load_dwordx2 v[40:41], v9, s[8:11], s26 offen sc1
  v_cmp_eq_u32 vcc, 20, v2
  v_mov_b32 v4, 0
  v_mov_b32 v5, 0x3f803f80
  v_cndmask_b32 v4, v4, v5, vcc
  v_mov_b32 v48, 0x3f803f80
  v_mov_b32 v49, 0x00003f80
  v_mov_b32 v52, v4
  v_mov_b32 v53, v4
  v_mov_b32 v54, v4
  v_mov_b32 v55, v4
  v_mov_b32 v56, v4
  v_mov_b32 v57, v4
  v_mov_b32 v58, v4
  v_mov_b32 v59, v4
  v_mov_b32 v64, 0x3f803f80
  v_mov_b32 v65, 0x00003f80
  v_mov_b32 v68, v4
  v_mov_b32 v69, v4
  v_mov_b32 v70, v4
  v_mov_b32 v71, v4
  v_mov_b32 v72, v4
  v_mov_b32 v73, v4
  v_mov_b32 v74, v4
  v_mov_b32 v75, v4
  s_add_u32 s64, s4, 20971520
  s_addc_u32 s65, s5, 0
  s_and_b32 s65, s65, 0xffff
  s_mov_b32 s66, 16384
  s_mov_b32 s67, 0x20000
  s_add_u32 s68, s4, 20975616
  s_addc_u32 s69, s5, 0
  s_load_dword s60, s[68:69], 0
  s_and_b32 s3, s2, 4
  s_cmp_eq_u32 s3, 0
  s_cselect_b32 s48, s48, s50
  s_cselect_b32 s49, s49, s51
  s_mov_b32 s56, s48
  s_and_b32 s57, s49, 0xffff
  s_mov_b32 s58, 819200
  s_mov_b32 s59, 0x20000
  s_lshr_b32 s3, s2, 3
  s_lshl_b32 s3, s3, 3
  s_add_u32 s3, s3, s22
  s_mul_i32 s3, s3, 3200
  s_add_u32 s48, s48, s3
  s_addc_u32 s49, s49, 0
  v_mul_u32_u24 v4, 6554, v1
  v_lshrrev_b32 v4, 16, v4
  v_mul_u32_u24 v5, 10, v4
  v_sub_u32 v5, v1, v5
  v_mul_u32_u24 v4, 1280, v4
  v_lshl_add_u32 v188, v5, 4, v4
  v_lshrrev_b32 v180, 4, v1
  v_and_b32 v181, 15, v1
  s_lshr_b32 s34, s2, 3
  s_lshr_b32 s35, s22, 2
  s_and_b32 s26, s2, 7
  s_lshl_b32 s26, s26, 3
  s_and_b32 s27, s22, 3
  s_lshl_b32 s27, s27, 1
  s_add_u32 s36, s26, s27
  s_and_b32 s37, s34, 1
  s_lshr_b32 s38, s34, 1
  s_mul_i32 s26, s37, 3
  v_add_u32 v4, s26, v180
  v_cmp_gt_u32 vcc, 2, v180
  v_mov_b32 v5, 2
  s_nop 0
  v_cndmask_b32 v4, v5, v4, vcc
  v_lshlrev_b32 v4, 14, v4
  s_mul_i32 s26, s38, 163840
  s_mul_i32 s27, s35, 81920
  s_add_u32 s26, s26, s27
  v_add_u32 v4, s26, v4
  v_lshl_add_u32 v182, v181, 4, v4
  v_lshrrev_b32 v5, 2, v181
  v_lshlrev_b32 v5, 3, v5
  v_and_b32 v6, 3, v181
  v_add_u32 v5, v5, v6
  v_lshl_add_u32 v183, v5, 4, v4
  v_add_u32 v184, 64, v183
  s_mul_i32 s26, s34, 81920
  s_mul_i32 s27, s35, 40960
  s_add_u32 s26, s26, s27
  v_mul_u32_u24 v4, 320, v180
  v_add_u32 v4, s26, v4
  v_min_u32 v5, 11, v181
  v_lshl_add_u32 v185, v5, 4, v4
  v_min_u32 v5, 7, v181
  v_add_u32 v5, 12, v5
  v_lshl_add_u32 v186, v5, 4, v4
  s_mul_i32 s26, s38, 5
  s_mul_i32 s27, s37, 3
  v_add_u32 v4, s27, v180
  v_cmp_gt_u32 vcc, 2, v180
  v_mov_b32 v5, 2
  s_nop 0
  v_cndmask_b32 v4, v5, v4, vcc
  v_add_u32 v4, s26, v4
  v_lshlrev_b32 v4, 9, v4
  s_lshl_b32 s27, s35, 8
  v_add_u32 v4, s27, v4
  v_lshl_add_u32 v4, v181, 4, v4
  s_lshl_b32 s27, s37, 3
  v_mov_b32 v5, s27
  v_cndmask_b32 v5, v5, 0, vcc
  v_add_u32 v187, v4, v5
  v_lshlrev_b32 v4, 3, v180
  v_add_u32 v4, 0, v4
  v_sub_u32 v5, v4, v181
  v_add_u32 v5, -9, v5
  v_mov_b32 v6, 0xf149f2ca
  v_cmp_gt_u32 vcc, 8, v5
  s_nop 1
  v_cndmask_b32 v192, v6, 0, vcc
  v_cmp_le_u32 vcc, 16, v4
  s_nop 1
  v_cndmask_b32 v200, v6, v192, vcc
  v_lshlrev_b32 v4, 3, v180
  v_add_u32 v4, 1, v4
  v_sub_u32 v5, v4, v181
  v_add_u32 v5, -9, v5
  v_mov_b32 v6, 0xf149f2ca
  v_cmp_gt_u32 vcc, 8, v5
  s_nop 1
  v_cndmask_b32 v193, v6, 0, vcc
  v_cmp_le_u32 vcc, 16, v4
  s_nop 1
  v_cndmask_b32 v201, v6, v193, vcc
  v_lshlrev_b32 v4, 3, v180
  v_add_u32 v4, 2, v4
  v_sub_u32 v5, v4, v181
  v_add_u32 v5, -9, v5
  v_mov_b32 v6, 0xf149f2ca
  v_cmp_gt_u32 vcc, 8, v5
  s_nop 1
  v_cndmask_b32 v194, v6, 0, vcc
  v_cmp_le_u32 vcc, 16, v4
  s_nop 1
  v_cndmask_b32 v202, v6, v194, vcc
  v_lshlrev_b32 v4, 3, v180
  v_add_u32 v4, 3, v4
  v_sub_u32 v5, v4, v181
  v_add_u32 v5, -9, v5
  v_mov_b32 v6, 0xf149f2ca
  v_cmp_gt_u32 vcc, 8, v5
  s_nop 1
  v_cndmask_b32 v195, v6, 0, vcc
  v_cmp_le_u32 vcc, 16, v4
  s_nop 1
  v_cndmask_b32 v203, v6, v195, vcc
  v_lshlrev_b32 v4, 3, v180
  v_add_u32 v4, 4, v4
  v_sub_u32 v5, v4, v181
  v_add_u32 v5, -9, v5
  v_mov_b32 v6, 0xf149f2ca
  v_cmp_gt_u32 vcc, 8, v5
  s_nop 1
  v_cndmask_b32 v196, v6, 0, vcc
  v_cmp_le_u32 vcc, 16, v4
  s_nop 1
  v_cndmask_b32 v204, v6, v196, vcc
  v_lshlrev_b32 v4, 3, v180
  v_add_u32 v4, 5, v4
  v_sub_u32 v5, v4, v181
  v_add_u32 v5, -9, v5
  v_mov_b32 v6, 0xf149f2ca
  v_cmp_gt_u32 vcc, 8, v5
  s_nop 1
  v_cndmask_b32 v197, v6, 0, vcc
  v_cmp_le_u32 vcc, 16, v4
  s_nop 1
  v_cndmask_b32 v205, v6, v197, vcc
  v_lshlrev_b32 v4, 3, v180
  v_add_u32 v4, 6, v4
  v_sub_u32 v5, v4, v181
  v_add_u32 v5, -9, v5
  v_mov_b32 v6, 0xf149f2ca
  v_cmp_gt_u32 vcc, 8, v5
  s_nop 1
  v_cndmask_b32 v198, v6, 0, vcc
  v_cmp_le_u32 vcc, 16, v4
  s_nop 1
  v_cndmask_b32 v206, v6, v198, vcc
  v_lshlrev_b32 v4, 3, v180
  v_add_u32 v4, 7, v4
  v_sub_u32 v5, v4, v181
  v_add_u32 v5, -9, v5
  v_mov_b32 v6, 0xf149f2ca
  v_cmp_gt_u32 vcc, 8, v5
  s_nop 1
  v_cndmask_b32 v199, v6, 0, vcc
  v_cmp_le_u32 vcc, 16, v4
  s_nop 1
  v_cndmask_b32 v207, v6, v199, vcc
  v_mov_b32 v208, 0x3f803f80
  v_mov_b32 v209, 0x3f803f80
  v_mov_b32 v210, 0x3f803f80
  v_mov_b32 v211, 0x3f803f80
  s_mov_b32 s28, 0
  s_waitcnt vmcnt(0)
  v_cmp_lt_u32 vcc, 31, v1
  s_nop 1
  v_cndmask_b32 v16, v16, 0, vcc
  v_cndmask_b32 v17, v17, 0, vcc
  v_mov_b32 v18, 0
  v_mov_b32 v19, 0
  v_cndmask_b32 v24, v24, 0, vcc
  v_cndmask_b32 v25, v25, 0, vcc
  v_mov_b32 v26, 0
  v_mov_b32 v27, 0
  v_cndmask_b32 v32, v32, 0, vcc
  v_cndmask_b32 v33, v33, 0, vcc
  v_mov_b32 v34, 0
  v_mov_b32 v35, 0
  v_cndmask_b32 v40, v40, 0, vcc
  v_cndmask_b32 v41, v41, 0, vcc
  v_mov_b32 v42, 0
  v_mov_b32 v43, 0
L_tail_kernel_a_main:
  s_mov_b32 s42, s24
  s_mov_b32 s43, s25
  buffer_load_dwordx4 v[44:47], v8, s[8:11], s42 offen sc1
  s_mov_b64 exec, s[32:33]
  buffer_load_dwordx2 v[48:49], v9, s[8:11], s42 offen sc1
  s_mov_b64 exec, -1
  s_mov_b64 exec, s[30:31]
  buffer_load_dwordx4 v[52:55], v10, s[8:11], s43 offen sc1
  buffer_load_dwordx4 v[56:59], v10, s[8:11], s43 offen offset:640 sc1
  s_mov_b64 exec, -1
L_tail_kernel_a_main2:
  v_mov_b32 v116, 0
  v_mov_b32 v117, 0
  v_mov_b32 v118, 0
  v_mov_b32 v119, 0
  v_mov_b32 v120, 0
  v_mov_b32 v121, 0
  v_mov_b32 v122, 0
  v_mov_b32 v123, 0
  v_mov_b32 v124, 0
  v_mov_b32 v125, 0
  v_mov_b32 v126, 0
  v_mov_b32 v127, 0
  v_mov_b32 v128, 0
  v_mov_b32 v129, 0
  v_mov_b32 v130, 0
  v_mov_b32 v131, 0
  v_mov_b32 v132, 0
  v_mov_b32 v133, 0
  v_mov_b32 v134, 0
  v_mov_b32 v135, 0
  v_mov_b32 v136, 0
  v_mov_b32 v137, 0
  v_mov_b32 v138, 0
  v_mov_b32 v139, 0
  v_mov_b32 v140, 0
  v_mov_b32 v141, 0
  v_mov_b32 v142, 0
  v_mov_b32 v143, 0
  v_mov_b32 v144, 0
  v_mov_b32 v145, 0
  v_mov_b32 v146, 0
  v_mov_b32 v147, 0
  v_mov_b32 v148, 0
  v_mov_b32 v149, 0
  v_mov_b32 v150, 0
  v_mov_b32 v151, 0
  v_mov_b32 v152, 0
  v_mov_b32 v153, 0
  v_mov_b32 v154, 0
  v_mov_b32 v155, 0
  v_mov_b32 v156, 0
  v_mov_b32 v157, 0
  v_mov_b32 v158, 0
  v_mov_b32 v159, 0
  v_mov_b32 v160, 0
  v_mov_b32 v161, 0
  v_mov_b32 v162, 0
  v_mov_b32 v163, 0
  v_mov_b32 v164, 0
  v_mov_b32 v165, 0
  v_mov_b32 v166, 0
  v_mov_b32 v167, 0
  v_mov_b32 v168, 0
  v_mov_b32 v169, 0
  v_mov_b32 v170, 0
  v_mov_b32 v171, 0
  v_mov_b32 v172, 0
  v_mov_b32 v173, 0
  v_mov_b32 v174, 0
  v_mov_b32 v175, 0
  v_mov_b32 v176, 0
  v_mov_b32 v177, 0
  v_mov_b32 v178, 0
  v_mov_b32 v179, 0
  v_mov_b32 v108, 0
  v_mov_b32 v109, 0
  v_mov_b32 v110, 0
  v_mov_b32 v111, 0
  v_mov_b32 v112, 0
  v_mov_b32 v113, 0
  v_mov_b32 v114, 0
  v_mov_b32 v115, 0
  s_waitcnt vmcnt(2)
  v_mfma_f32_32x32x16_bf16 v[76:91], v[44:47], v[12:15], 0
  v_mfma_f32_32x32x8_bf16 v[76:91], v[48:49], v[16:17], v[76:91]
  s_nop 7
  s_nop 7
  s_mul_i32 s53, s22, 640
  s_and_b32 s3, s22, 1
  s_lshl_b32 s3, s3, 1
  s_bfe_u32 s54, s22, 0x10001
  s_or_b32 s3, s3, s54
  s_and_b32 s54, s22, 4
  s_or_b32 s3, s3, s54
  s_mul_i32 s54, s3, 5120
  s_lshr_b32 s3, s2, 5
  s_mul_i32 s3, s3, 160
  s_add_u32 s54, s54, s3
  s_add_u32 s55, s53, 81920
  s_add_u32 s29, s54, 655360
  s_setprio 3
  s_mov_b32 s44, 2
  .p2align 6
L_tail_kernel_a_loop0:
  s_add_u32 s42, s42, 2560
  buffer_load_dwordx4 v[60:63], v8, s[8:11], s42 offen sc1
  s_mov_b64 exec, s[32:33]
  buffer_load_dwordx2 v[64:65], v9, s[8:11], s42 offen sc1
  s_mov_b64 exec, -1
  v_mfma_f32_32x32x16_bf16 v[164:179], v[68:71], v[108:111], v[164:179]
  v_exp_f32 v76, v76
  v_exp_f32 v77, v77
  v_exp_f32 v78, v78
  v_exp_f32 v79, v79
  v_mfma_f32_32x32x16_bf16 v[92:107], v[44:47], v[20:23], 0
  v_exp_f32 v80, v80
  v_exp_f32 v81, v81
  v_exp_f32 v82, v82
  v_exp_f32 v83, v83
  v_cvt_pk_bf16_f32 v108, v76, v77
  v_cvt_pk_bf16_f32 v109, v78, v79
  v_mfma_f32_32x32x8_bf16 v[92:107], v[48:49], v[24:25], v[92:107]
  v_exp_f32 v84, v84
  v_exp_f32 v85, v85
  v_exp_f32 v86, v86
  v_exp_f32 v87, v87
  v_cvt_pk_bf16_f32 v110, v80, v81
  v_cvt_pk_bf16_f32 v111, v82, v83
  v_mfma_f32_32x32x16_bf16 v[164:179], v[72:75], v[112:115], v[164:179]
  v_exp_f32 v88, v88
  v_exp_f32 v89, v89
  v_exp_f32 v90, v90
  v_exp_f32 v91, v91
  v_cvt_pk_bf16_f32 v112, v84, v85
  v_cvt_pk_bf16_f32 v113, v86, v87
  v_cvt_pk_bf16_f32 v114, v88, v89
  v_cvt_pk_bf16_f32 v115, v90, v91
  s_add_u32 s43, s43, 1280
  s_mov_b64 exec, s[30:31]
  buffer_load_dwordx4 v[68:71], v10, s[8:11], s43 offen sc1
  buffer_load_dwordx4 v[72:75], v10, s[8:11], s43 offen offset:640 sc1
  s_mov_b64 exec, -1
  s_waitcnt vmcnt(4)
  v_mfma_f32_32x32x16_bf16 v[116:131], v[52:55], v[108:111], v[116:131]
  v_exp_f32 v92, v92
  v_exp_f32 v93, v93
  v_exp_f32 v94, v94
  v_exp_f32 v95, v95
  v_mfma_f32_32x32x16_bf16 v[76:91], v[44:47], v[28:31], 0
  v_exp_f32 v96, v96
  v_exp_f32 v97, v97
  v_exp_f32 v98, v98
  v_exp_f32 v99, v99
  v_cvt_pk_bf16_f32 v108, v92, v93
  v_cvt_pk_bf16_f32 v109, v94, v95
  v_mfma_f32_32x32x8_bf16 v[76:91], v[48:49], v[32:33], v[76:91]
  v_exp_f32 v100, v100
  v_exp_f32 v101, v101
  v_exp_f32 v102, v102
  v_exp_f32 v103, v103
  v_cvt_pk_bf16_f32 v110, v96, v97
  v_cvt_pk_bf16_f32 v111, v98, v99
  v_mfma_f32_32x32x16_bf16 v[116:131], v[56:59], v[112:115], v[116:131]
  v_exp_f32 v104, v104
  v_exp_f32 v105, v105
  v_exp_f32 v106, v106
  v_exp_f32 v107, v107
  v_cvt_pk_bf16_f32 v112, v100, v101
  v_cvt_pk_bf16_f32 v113, v102, v103
  v_cvt_pk_bf16_f32 v114, v104, v105
  v_cvt_pk_bf16_f32 v115, v106, v107
  v_mfma_f32_32x32x16_bf16 v[132:147], v[52:55], v[108:111], v[132:147]
  v_exp_f32 v76, v76
  v_exp_f32 v77, v77
  v_exp_f32 v78, v78
  v_exp_f32 v79, v79
  v_mfma_f32_32x32x16_bf16 v[92:107], v[44:47], v[36:39], 0
  v_exp_f32 v80, v80
  v_exp_f32 v81, v81
  v_exp_f32 v82, v82
  v_exp_f32 v83, v83
  v_cvt_pk_bf16_f32 v108, v76, v77
  v_cvt_pk_bf16_f32 v109, v78, v79
  v_mfma_f32_32x32x8_bf16 v[92:107], v[48:49], v[40:41], v[92:107]
  v_exp_f32 v84, v84
  v_exp_f32 v85, v85
  v_exp_f32 v86, v86
  v_exp_f32 v87, v87
  v_cvt_pk_bf16_f32 v110, v80, v81
  v_cvt_pk_bf16_f32 v111, v82, v83
  v_mfma_f32_32x32x16_bf16 v[132:147], v[56:59], v[112:115], v[132:147]
  v_exp_f32 v88, v88
  v_exp_f32 v89, v89
  v_exp_f32 v90, v90
  v_exp_f32 v91, v91
  v_cvt_pk_bf16_f32 v112, v84, v85
  v_cvt_pk_bf16_f32 v113, v86, v87
  v_cvt_pk_bf16_f32 v114, v88, v89
  v_cvt_pk_bf16_f32 v115, v90, v91
  s_waitcnt vmcnt(2)
  v_mfma_f32_32x32x16_bf16 v[148:163], v[52:55], v[108:111], v[148:163]
  v_exp_f32 v92, v92
  v_exp_f32 v93, v93
  v_exp_f32 v94, v94
  v_exp_f32 v95, v95
  v_mfma_f32_32x32x16_bf16 v[76:91], v[60:63], v[12:15], 0
  v_exp_f32 v96, v96
  v_exp_f32 v97, v97
  v_exp_f32 v98, v98
  v_exp_f32 v99, v99
  v_cvt_pk_bf16_f32 v108, v92, v93
  v_cvt_pk_bf16_f32 v109, v94, v95
  v_mfma_f32_32x32x8_bf16 v[76:91], v[64:65], v[16:17], v[76:91]
  v_exp_f32 v100, v100
  v_exp_f32 v101, v101
  v_exp_f32 v102, v102
  v_exp_f32 v103, v103
  v_cvt_pk_bf16_f32 v110, v96, v97
  v_cvt_pk_bf16_f32 v111, v98, v99
  v_mfma_f32_32x32x16_bf16 v[148:163], v[56:59], v[112:115], v[148:163]
  v_exp_f32 v104, v104
  v_exp_f32 v105, v105
  v_exp_f32 v106, v106
  v_exp_f32 v107, v107
  v_cvt_pk_bf16_f32 v112, v100, v101
  v_cvt_pk_bf16_f32 v113, v102, v103
  v_cvt_pk_bf16_f32 v114, v104, v105
  v_cvt_pk_bf16_f32 v115, v106, v107
  s_add_u32 s42, s42, 2560
  buffer_load_dwordx4 v[44:47], v8, s[8:11], s42 offen sc1
  s_mov_b64 exec, s[32:33]
  buffer_load_dwordx2 v[48:49], v9, s[8:11], s42 offen sc1
  s_mov_b64 exec, -1
  v_mfma_f32_32x32x16_bf16 v[164:179], v[52:55], v[108:111], v[164:179]
  v_exp_f32 v76, v76
  v_exp_f32 v77, v77
  v_exp_f32 v78, v78
  v_exp_f32 v79, v79
  v_mfma_f32_32x32x16_bf16 v[92:107], v[60:63], v[20:23], 0
  v_exp_f32 v80, v80
  v_exp_f32 v81, v81
  v_exp_f32 v82, v82
  v_exp_f32 v83, v83
  v_cvt_pk_bf16_f32 v108, v76, v77
  v_cvt_pk_bf16_f32 v109, v78, v79
  v_mfma_f32_32x32x8_bf16 v[92:107], v[64:65], v[24:25], v[92:107]
  v_exp_f32 v84, v84
  v_exp_f32 v85, v85
  v_exp_f32 v86, v86
  v_exp_f32 v87, v87
  v_cvt_pk_bf16_f32 v110, v80, v81
  v_cvt_pk_bf16_f32 v111, v82, v83
  v_mfma_f32_32x32x16_bf16 v[164:179], v[56:59], v[112:115], v[164:179]
  v_exp_f32 v88, v88
  v_exp_f32 v89, v89
  v_exp_f32 v90, v90
  v_exp_f32 v91, v91
  v_cvt_pk_bf16_f32 v112, v84, v85
  v_cvt_pk_bf16_f32 v113, v86, v87
  v_cvt_pk_bf16_f32 v114, v88, v89
  v_cvt_pk_bf16_f32 v115, v90, v91
  s_add_u32 s43, s43, 1280
  s_mov_b64 exec, s[30:31]
  buffer_load_dwordx4 v[52:55], v10, s[8:11], s43 offen sc1
  buffer_load_dwordx4 v[56:59], v10, s[8:11], s43 offen offset:640 sc1
  s_mov_b64 exec, -1
  s_waitcnt vmcnt(4)
  v_mfma_f32_32x32x16_bf16 v[116:131], v[68:71], v[108:111], v[116:131]
  v_exp_f32 v92, v92
  v_exp_f32 v93, v93
  v_exp_f32 v94, v94
  v_exp_f32 v95, v95
  v_mfma_f32_32x32x16_bf16 v[76:91], v[60:63], v[28:31], 0
  v_exp_f32 v96, v96
  v_exp_f32 v97, v97
  v_exp_f32 v98, v98
  v_exp_f32 v99, v99
  v_cvt_pk_bf16_f32 v108, v92, v93
  v_cvt_pk_bf16_f32 v109, v94, v95
  v_mfma_f32_32x32x8_bf16 v[76:91], v[64:65], v[32:33], v[76:91]
  v_exp_f32 v100, v100
  v_exp_f32 v101, v101
  v_exp_f32 v102, v102
  v_exp_f32 v103, v103
  v_cvt_pk_bf16_f32 v110, v96, v97
  v_cvt_pk_bf16_f32 v111, v98, v99
  v_mfma_f32_32x32x16_bf16 v[116:131], v[72:75], v[112:115], v[116:131]
  v_exp_f32 v104, v104
  v_exp_f32 v105, v105
  v_exp_f32 v106, v106
  v_exp_f32 v107, v107
  v_cvt_pk_bf16_f32 v112, v100, v101
  v_cvt_pk_bf16_f32 v113, v102, v103
  v_cvt_pk_bf16_f32 v114, v104, v105
  v_cvt_pk_bf16_f32 v115, v106, v107
  v_mfma_f32_32x32x16_bf16 v[132:147], v[68:71], v[108:111], v[132:147]
  v_exp_f32 v76, v76
  v_exp_f32 v77, v77
  v_exp_f32 v78, v78
  v_exp_f32 v79, v79
  v_mfma_f32_32x32x16_bf16 v[92:107], v[60:63], v[36:39], 0
  v_exp_f32 v80, v80
  v_exp_f32 v81, v81
  v_exp_f32 v82, v82
  v_exp_f32 v83, v83
  v_cvt_pk_bf16_f32 v108, v76, v77
  v_cvt_pk_bf16_f32 v109, v78, v79
  v_mfma_f32_32x32x8_bf16 v[92:107], v[64:65], v[40:41], v[92:107]
  v_exp_f32 v84, v84
  v_exp_f32 v85, v85
  v_exp_f32 v86, v86
  v_exp_f32 v87, v87
  v_cvt_pk_bf16_f32 v110, v80, v81
  v_cvt_pk_bf16_f32 v111, v82, v83
  v_mfma_f32_32x32x16_bf16 v[132:147], v[72:75], v[112:115], v[132:147]
  v_exp_f32 v88, v88
  v_exp_f32 v89, v89
  v_exp_f32 v90, v90
  v_exp_f32 v91, v91
  v_cvt_pk_bf16_f32 v112, v84, v85
  v_cvt_pk_bf16_f32 v113, v86, v87
  v_cvt_pk_bf16_f32 v114, v88, v89
  v_cvt_pk_bf16_f32 v115, v90, v91
  s_waitcnt vmcnt(2)
  v_mfma_f32_32x32x16_bf16 v[148:163], v[68:71], v[108:111], v[148:163]
  v_exp_f32 v92, v92
  v_exp_f32 v93, v93
  v_exp_f32 v94, v94
  v_exp_f32 v95, v95
  v_mfma_f32_32x32x16_bf16 v[76:91], v[44:47], v[12:15], 0
  v_exp_f32 v96, v96
  v_exp_f32 v97, v97
  v_exp_f32 v98, v98
  v_exp_f32 v99, v99
  v_cvt_pk_bf16_f32 v108, v92, v93
  v_cvt_pk_bf16_f32 v109, v94, v95
  v_mfma_f32_32x32x8_bf16 v[76:91], v[48:49], v[16:17], v[76:91]
  v_exp_f32 v100, v100
  v_exp_f32 v101, v101
  v_exp_f32 v102, v102
  v_exp_f32 v103, v103
  v_cvt_pk_bf16_f32 v110, v96, v97
  v_cvt_pk_bf16_f32 v111, v98, v99
  v_mfma_f32_32x32x16_bf16 v[148:163], v[72:75], v[112:115], v[148:163]
  v_exp_f32 v104, v104
  v_exp_f32 v105, v105
  v_exp_f32 v106, v106
  v_exp_f32 v107, v107
  v_cvt_pk_bf16_f32 v112, v100, v101
  v_cvt_pk_bf16_f32 v113, v102, v103
  v_cvt_pk_bf16_f32 v114, v104, v105
  v_cvt_pk_bf16_f32 v115, v106, v107
  s_sub_u32 s44, s44, 1
  s_cmp_lg_u32 s44, 0
  s_cbranch_scc1 L_tail_kernel_a_loop0
  s_mov_b32 s44, 6
  .p2align 6
L_tail_kernel_a_loop1:
  s_cmp_eq_u32 s44, 4
  s_cbranch_scc0 L_tail_kernel_a_loop1p4
  s_setprio 2
L_tail_kernel_a_loop1p4:
  s_cmp_eq_u32 s44, 2
  s_cbranch_scc0 L_tail_kernel_a_loop1p2
  s_setprio 1
L_tail_kernel_a_loop1p2:
  s_add_u32 s42, s42, 2560
  buffer_load_dwordx4 v[60:63], v8, s[8:11], s42 offen sc1
  s_mov_b64 exec, s[32:33]
  buffer_load_dwordx2 v[64:65], v9, s[8:11], s42 offen sc1
  s_mov_b64 exec, -1
  s_mov_b32 m0, s53
  s_mov_b32 exec_lo, -1
  s_mov_b32 exec_hi, 0xff
  buffer_load_dwordx4 v188, s[56:59], s54 offen lds
  s_mov_b64 exec, -1
  s_add_u32 s53, s53, 5120
  s_add_u32 s54, s54, 40960
  s_min_u32 s53, s53, s55
  s_min_u32 s54, s54, s29
  v_mfma_f32_32x32x16_bf16 v[164:179], v[68:71], v[108:111], v[164:179]
  v_exp_f32 v76, v76
  v_exp_f32 v77, v77
  v_exp_f32 v78, v78
  v_exp_f32 v79, v79
  v_mfma_f32_32x32x16_bf16 v[92:107], v[44:47], v[20:23], 0
  v_exp_f32 v80, v80
  v_exp_f32 v81, v81
  v_exp_f32 v82, v82
  v_exp_f32 v83, v83
  v_cvt_pk_bf16_f32 v108, v76, v77
  v_cvt_pk_bf16_f32 v109, v78, v79
  v_mfma_f32_32x32x8_bf16 v[92:107], v[48:49], v[24:25], v[92:107]
  v_exp_f32 v84, v84
  v_exp_f32 v85, v85
  v_exp_f32 v86, v86
  v_exp_f32 v87, v87
  v_cvt_pk_bf16_f32 v110, v80, v81
  v_cvt_pk_bf16_f32 v111, v82, v83
  v_mfma_f32_32x32x16_bf16 v[164:179], v[72:75], v[112:115], v[164:179]
  v_exp_f32 v88, v88
  v_exp_f32 v89, v89
  v_exp_f32 v90, v90
  v_exp_f32 v91, v91
  v_cvt_pk_bf16_f32 v112, v84, v85
  v_cvt_pk_bf16_f32 v113, v86, v87
  v_cvt_pk_bf16_f32 v114, v88, v89
  v_cvt_pk_bf16_f32 v115, v90, v91
  s_add_u32 s43, s43, 1280
  s_mov_b64 exec, s[30:31]
  buffer_load_dwordx4 v[68:71], v10, s[8:11], s43 offen sc1
  buffer_load_dwordx4 v[72:75], v10, s[8:11], s43 offen offset:640 sc1
  s_mov_b64 exec, -1
  s_waitcnt vmcnt(5)
  v_mfma_f32_32x32x16_bf16 v[116:131], v[52:55], v[108:111], v[116:131]
  v_exp_f32 v92, v92
  v_exp_f32 v93, v93
  v_exp_f32 v94, v94
  v_exp_f32 v95, v95
  v_mfma_f32_32x32x16_bf16 v[76:91], v[44:47], v[28:31], 0
  v_exp_f32 v96, v96
  v_exp_f32 v97, v97
  v_exp_f32 v98, v98
  v_exp_f32 v99, v99
  v_cvt_pk_bf16_f32 v108, v92, v93
  v_cvt_pk_bf16_f32 v109, v94, v95
  v_mfma_f32_32x32x8_bf16 v[76:91], v[48:49], v[32:33], v[76:91]
  v_exp_f32 v100, v100
  v_exp_f32 v101, v101
  v_exp_f32 v102, v102
  v_exp_f32 v103, v103
  v_cvt_pk_bf16_f32 v110, v96, v97
  v_cvt_pk_bf16_f32 v111, v98, v99
  v_mfma_f32_32x32x16_bf16 v[116:131], v[56:59], v[112:115], v[116:131]
  v_exp_f32 v104, v104
  v_exp_f32 v105, v105
  v_exp_f32 v106, v106
  v_exp_f32 v107, v107
  v_cvt_pk_bf16_f32 v112, v100, v101
  v_cvt_pk_bf16_f32 v113, v102, v103
  v_cvt_pk_bf16_f32 v114, v104, v105
  v_cvt_pk_bf16_f32 v115, v106, v107
  v_mfma_f32_32x32x16_bf16 v[132:147], v[52:55], v[108:111], v[132:147]
  v_exp_f32 v76, v76
  v_exp_f32 v77, v77
  v_exp_f32 v78, v78
  v_exp_f32 v79, v79
  v_mfma_f32_32x32x16_bf16 v[92:107], v[44:47], v[36:39], 0
  v_exp_f32 v80, v80
  v_exp_f32 v81, v81
  v_exp_f32 v82, v82
  v_exp_f32 v83, v83
  v_cvt_pk_bf16_f32 v108, v76, v77
  v_cvt_pk_bf16_f32 v109, v78, v79
  v_mfma_f32_32x32x8_bf16 v[92:107], v[48:49], v[40:41], v[92:107]
  v_exp_f32 v84, v84
  v_exp_f32 v85, v85
  v_exp_f32 v86, v86
  v_exp_f32 v87, v87
  v_cvt_pk_bf16_f32 v110, v80, v81
  v_cvt_pk_bf16_f32 v111, v82, v83
  v_mfma_f32_32x32x16_bf16 v[132:147], v[56:59], v[112:115], v[132:147]
  v_exp_f32 v88, v88
  v_exp_f32 v89, v89
  v_exp_f32 v90, v90
  v_exp_f32 v91, v91
  v_cvt_pk_bf16_f32 v112, v84, v85
  v_cvt_pk_bf16_f32 v113, v86, v87
  v_cvt_pk_bf16_f32 v114, v88, v89
  v_cvt_pk_bf16_f32 v115, v90, v91
  s_waitcnt vmcnt(3)
  v_mfma_f32_32x32x16_bf16 v[148:163], v[52:55], v[108:111], v[148:163]
  v_exp_f32 v92, v92
  v_exp_f32 v93, v93
  v_exp_f32 v94, v94
  v_exp_f32 v95, v95
  v_mfma_f32_32x32x16_bf16 v[76:91], v[60:63], v[12:15], 0
  v_exp_f32 v96, v96
  v_exp_f32 v97, v97
  v_exp_f32 v98, v98
  v_exp_f32 v99, v99
  v_cvt_pk_bf16_f32 v108, v92, v93
  v_cvt_pk_bf16_f32 v109, v94, v95
  v_mfma_f32_32x32x8_bf16 v[76:91], v[64:65], v[16:17], v[76:91]
  v_exp_f32 v100, v100
  v_exp_f32 v101, v101
  v_exp_f32 v102, v102
  v_exp_f32 v103, v103
  v_cvt_pk_bf16_f32 v110, v96, v97
  v_cvt_pk_bf16_f32 v111, v98, v99
  v_mfma_f32_32x32x16_bf16 v[148:163], v[56:59], v[112:115], v[148:163]
  v_exp_f32 v104, v104
  v_exp_f32 v105, v105
  v_exp_f32 v106, v106
  v_exp_f32 v107, v107
  v_cvt_pk_bf16_f32 v112, v100, v101
  v_cvt_pk_bf16_f32 v113, v102, v103
  v_cvt_pk_bf16_f32 v114, v104, v105
  v_cvt_pk_bf16_f32 v115, v106, v107
  s_cmp_eq_u32 s44, 1
  s_cbranch_scc0 L_tail_kernel_a_loop1m1
  s_setprio 0
L_tail_kernel_a_loop1m1:
  s_add_u32 s42, s42, 2560
  buffer_load_dwordx4 v[44:47], v8, s[8:11], s42 offen sc1
  s_mov_b64 exec, s[32:33]
  buffer_load_dwordx2 v[48:49], v9, s[8:11], s42 offen sc1
  s_mov_b64 exec, -1
  s_mov_b32 m0, s53
  s_mov_b32 exec_lo, -1
  s_mov_b32 exec_hi, 0xff
  buffer_load_dwordx4 v188, s[56:59], s54 offen lds
  s_mov_b64 exec, -1
  s_add_u32 s53, s53, 5120
  s_add_u32 s54, s54, 40960
  s_min_u32 s53, s53, s55
  s_min_u32 s54, s54, s29
  s_mov_b32 m0, s53
  s_mov_b32 exec_lo, -1
  s_mov_b32 exec_hi, 0xff
  buffer_load_dwordx4 v188, s[56:59], s54 offen lds
  s_mov_b64 exec, -1
  s_add_u32 s53, s53, 5120
  s_add_u32 s54, s54, 40960
  s_min_u32 s53, s53, s55
  s_min_u32 s54, s54, s29
  v_mfma_f32_32x32x16_bf16 v[164:179], v[52:55], v[108:111], v[164:179]
  v_exp_f32 v76, v76
  v_exp_f32 v77, v77
  v_exp_f32 v78, v78
  v_exp_f32 v79, v79
  v_mfma_f32_32x32x16_bf16 v[92:107], v[60:63], v[20:23], 0
  v_exp_f32 v80, v80
  v_exp_f32 v81, v81
  v_exp_f32 v82, v82
  v_exp_f32 v83, v83
  v_cvt_pk_bf16_f32 v108, v76, v77
  v_cvt_pk_bf16_f32 v109, v78, v79
  v_mfma_f32_32x32x8_bf16 v[92:107], v[64:65], v[24:25], v[92:107]
  v_exp_f32 v84, v84
  v_exp_f32 v85, v85
  v_exp_f32 v86, v86
  v_exp_f32 v87, v87
  v_cvt_pk_bf16_f32 v110, v80, v81
  v_cvt_pk_bf16_f32 v111, v82, v83
  v_mfma_f32_32x32x16_bf16 v[164:179], v[56:59], v[112:115], v[164:179]
  v_exp_f32 v88, v88
  v_exp_f32 v89, v89
  v_exp_f32 v90, v90
  v_exp_f32 v91, v91
  v_cvt_pk_bf16_f32 v112, v84, v85
  v_cvt_pk_bf16_f32 v113, v86, v87
  v_cvt_pk_bf16_f32 v114, v88, v89
  v_cvt_pk_bf16_f32 v115, v90, v91
  s_add_u32 s43, s43, 1280
  s_mov_b64 exec, s[30:31]
  buffer_load_dwordx4 v[52:55], v10, s[8:11], s43 offen sc1
  buffer_load_dwordx4 v[56:59], v10, s[8:11], s43 offen offset:640 sc1
  s_mov_b64 exec, -1
  s_waitcnt vmcnt(6)
  v_mfma_f32_32x32x16_bf16 v[116:131], v[68:71], v[108:111], v[116:131]
  v_exp_f32 v92, v92
  v_exp_f32 v93, v93
  v_exp_f32 v94, v94
  v_exp_f32 v95, v95
  v_mfma_f32_32x32x16_bf16 v[76:91], v[60:63], v[28:31], 0
  v_exp_f32 v96, v96
  v_exp_f32 v97, v97
  v_exp_f32 v98, v98
  v_exp_f32 v99, v99
  v_cvt_pk_bf16_f32 v108, v92, v93
  v_cvt_pk_bf16_f32 v109, v94, v95
  v_mfma_f32_32x32x8_bf16 v[76:91], v[64:65], v[32:33], v[76:91]
  v_exp_f32 v100, v100
  v_exp_f32 v101, v101
  v_exp_f32 v102, v102
  v_exp_f32 v103, v103
  v_cvt_pk_bf16_f32 v110, v96, v97
  v_cvt_pk_bf16_f32 v111, v98, v99
  v_mfma_f32_32x32x16_bf16 v[116:131], v[72:75], v[112:115], v[116:131]
  v_exp_f32 v104, v104
  v_exp_f32 v105, v105
  v_exp_f32 v106, v106
  v_exp_f32 v107, v107
  v_cvt_pk_bf16_f32 v112, v100, v101
  v_cvt_pk_bf16_f32 v113, v102, v103
  v_cvt_pk_bf16_f32 v114, v104, v105
  v_cvt_pk_bf16_f32 v115, v106, v107
  v_mfma_f32_32x32x16_bf16 v[132:147], v[68:71], v[108:111], v[132:147]
  v_exp_f32 v76, v76
  v_exp_f32 v77, v77
  v_exp_f32 v78, v78
  v_exp_f32 v79, v79
  v_mfma_f32_32x32x16_bf16 v[92:107], v[60:63], v[36:39], 0
  v_exp_f32 v80, v80
  v_exp_f32 v81, v81
  v_exp_f32 v82, v82
  v_exp_f32 v83, v83
  v_cvt_pk_bf16_f32 v108, v76, v77
  v_cvt_pk_bf16_f32 v109, v78, v79
  v_mfma_f32_32x32x8_bf16 v[92:107], v[64:65], v[40:41], v[92:107]
  v_exp_f32 v84, v84
  v_exp_f32 v85, v85
  v_exp_f32 v86, v86
  v_exp_f32 v87, v87
  v_cvt_pk_bf16_f32 v110, v80, v81
  v_cvt_pk_bf16_f32 v111, v82, v83
  v_mfma_f32_32x32x16_bf16 v[132:147], v[72:75], v[112:115], v[132:147]
  v_exp_f32 v88, v88
  v_exp_f32 v89, v89
  v_exp_f32 v90, v90
  v_exp_f32 v91, v91
  v_cvt_pk_bf16_f32 v112, v84, v85
  v_cvt_pk_bf16_f32 v113, v86, v87
  v_cvt_pk_bf16_f32 v114, v88, v89
  v_cvt_pk_bf16_f32 v115, v90, v91
  s_waitcnt vmcnt(4)
  v_mfma_f32_32x32x16_bf16 v[148:163], v[68:71], v[108:111], v[148:163]
  v_exp_f32 v92, v92
  v_exp_f32 v93, v93
  v_exp_f32 v94, v94
  v_exp_f32 v95, v95
  v_mfma_f32_32x32x16_bf16 v[76:91], v[44:47], v[12:15], 0
  v_exp_f32 v96, v96
  v_exp_f32 v97, v97
  v_exp_f32 v98, v98
  v_exp_f32 v99, v99
  v_cvt_pk_bf16_f32 v108, v92, v93
  v_cvt_pk_bf16_f32 v109, v94, v95
  v_mfma_f32_32x32x8_bf16 v[76:91], v[48:49], v[16:17], v[76:91]
  v_exp_f32 v100, v100
  v_exp_f32 v101, v101
  v_exp_f32 v102, v102
  v_exp_f32 v103, v103
  v_cvt_pk_bf16_f32 v110, v96, v97
  v_cvt_pk_bf16_f32 v111, v98, v99
  v_mfma_f32_32x32x16_bf16 v[148:163], v[72:75], v[112:115], v[148:163]
  v_exp_f32 v104, v104
  v_exp_f32 v105, v105
  v_exp_f32 v106, v106
  v_exp_f32 v107, v107
  v_cvt_pk_bf16_f32 v112, v100, v101
  v_cvt_pk_bf16_f32 v113, v102, v103
  v_cvt_pk_bf16_f32 v114, v104, v105
  v_cvt_pk_bf16_f32 v115, v106, v107
  s_sub_u32 s44, s44, 1
  s_cmp_lg_u32 s44, 0
  s_cbranch_scc1 L_tail_kernel_a_loop1
  s_nop 1
  v_mfma_f32_32x32x16_bf16 v[164:179], v[68:71], v[108:111], v[164:179]
  v_mfma_f32_32x32x16_bf16 v[164:179], v[72:75], v[112:115], v[164:179]
  s_add_u32 s26, s36, 0
  s_lshl_b32 s48, s26, 8
  s_add_u32 s48, s48, 7864320
  s_sub_u32 s49, s26, 1
  s_lshl_b32 s50, s49, 8
  s_add_u32 s50, s50, 10485760
  s_mul_i32 s51, s49, 640
  s_add_u32 s51, s51, 13107200
  buffer_load_dwordx4 v[212:215], v182, s[8:11], s48 offen sc1
  buffer_load_dwordx4 v[216:219], v183, s[8:11], s50 offen sc1
  buffer_load_dwordx4 v[220:223], v184, s[8:11], s50 offen sc1
  buffer_load_dwordx4 v[224:227], v185, s[8:11], s51 offen sc1
  buffer_load_dwordx4 v[228:231], v186, s[8:11], s51 offen sc1
  s_add_u32 s26, s36, 1
  s_lshl_b32 s48, s26, 8
  s_add_u32 s48, s48, 7864320
  s_sub_u32 s49, s26, 1
  s_lshl_b32 s50, s49, 8
  s_add_u32 s50, s50, 10485760
  s_mul_i32 s51, s49, 640
  s_add_u32 s51, s51, 13107200
  buffer_load_dwordx4 v[232:235], v182, s[8:11], s48 offen sc1
  buffer_load_dwordx4 v[236:239], v183, s[8:11], s50 offen sc1
  buffer_load_dwordx4 v[240:243], v184, s[8:11], s50 offen sc1
  buffer_load_dwordx4 v[244:247], v185, s[8:11], s51 offen sc1
  buffer_load_dwordx4 v[248:251], v186, s[8:11], s51 offen sc1
  s_and_b32 s45, s22, 3
  s_lshr_b32 s46, s22, 2
  v_lshlrev_b32 v11, 4, v1
  s_mul_i32 s26, s46, 36864
  s_add_u32 s26, s26, 87040
  v_add_u32 v4, s26, v11
L_tail_kernel_a_cw0:
  s_cmp_eq_u32 s45, 0
  s_cbranch_scc0 L_tail_kernel_a_cw1
  ds_write_b128 v4, v[132:135] offset:15360
  ds_write_b128 v4, v[136:139] offset:16384
  ds_write_b128 v4, v[140:143] offset:17408
  ds_write_b128 v4, v[148:151] offset:21504
  ds_write_b128 v4, v[152:155] offset:22528
  ds_write_b128 v4, v[156:159] offset:23552
  ds_write_b128 v4, v[164:167] offset:27648
  ds_write_b128 v4, v[168:171] offset:28672
  ds_write_b128 v4, v[172:175] offset:29696
  v_mov_b32 v76, v116
  v_mov_b32 v77, v117
  v_mov_b32 v78, v118
  v_mov_b32 v79, v119
  v_mov_b32 v80, v120
  v_mov_b32 v81, v121
  v_mov_b32 v82, v122
  v_mov_b32 v83, v123
  v_mov_b32 v84, v124
  v_mov_b32 v85, v125
  v_mov_b32 v86, v126
  v_mov_b32 v87, v127
  s_branch L_tail_kernel_a_cwd
L_tail_kernel_a_cw1:
  s_cmp_eq_u32 s45, 1
  s_cbranch_scc0 L_tail_kernel_a_cw2
  ds_write_b128 v4, v[116:119] offset:0
  ds_write_b128 v4, v[120:123] offset:1024
  ds_write_b128 v4, v[124:127] offset:2048
  ds_write_b128 v4, v[148:151] offset:24576
  ds_write_b128 v4, v[152:155] offset:25600
  ds_write_b128 v4, v[156:159] offset:26624
  ds_write_b128 v4, v[164:167] offset:30720
  ds_write_b128 v4, v[168:171] offset:31744
  ds_write_b128 v4, v[172:175] offset:32768
  v_mov_b32 v76, v132
  v_mov_b32 v77, v133
  v_mov_b32 v78, v134
  v_mov_b32 v79, v135
  v_mov_b32 v80, v136
  v_mov_b32 v81, v137
  v_mov_b32 v82, v138
  v_mov_b32 v83, v139
  v_mov_b32 v84, v140
  v_mov_b32 v85, v141
  v_mov_b32 v86, v142
  v_mov_b32 v87, v143
  s_branch L_tail_kernel_a_cwd
L_tail_kernel_a_cw2:
  s_cmp_eq_u32 s45, 2
  s_cbranch_scc0 L_tail_kernel_a_cw3
  ds_write_b128 v4, v[116:119] offset:3072
  ds_write_b128 v4, v[120:123] offset:4096
  ds_write_b128 v4, v[124:127] offset:5120
  ds_write_b128 v4, v[132:135] offset:9216
  ds_write_b128 v4, v[136:139] offset:10240
  ds_write_b128 v4, v[140:143] offset:11264
  ds_write_b128 v4, v[164:167] offset:33792
  ds_write_b128 v4, v[168:171] offset:34816
  ds_write_b128 v4, v[172:175] offset:35840
  v_mov_b32 v76, v148
  v_mov_b32 v77, v149
  v_mov_b32 v78, v150
  v_mov_b32 v79, v151
  v_mov_b32 v80, v152
  v_mov_b32 v81, v153
  v_mov_b32 v82, v154
  v_mov_b32 v83, v155
  v_mov_b32 v84, v156
  v_mov_b32 v85, v157
  v_mov_b32 v86, v158
  v_mov_b32 v87, v159
  s_branch L_tail_kernel_a_cwd
L_tail_kernel_a_cw3:
  ds_write_b128 v4, v[116:119] offset:6144
  ds_write_b128 v4, v[120:123] offset:7168
  ds_write_b128 v4, v[124:127] offset:8192
  ds_write_b128 v4, v[132:135] offset:12288
  ds_write_b128 v4, v[136:139] offset:13312
  ds_write_b128 v4, v[140:143] offset:14336
  ds_write_b128 v4, v[148:151] offset:18432
  ds_write_b128 v4, v[152:155] offset:19456
  ds_write_b128 v4, v[156:159] offset:20480
  v_mov_b32 v76, v164
  v_mov_b32 v77, v165
  v_mov_b32 v78, v166
  v_mov_b32 v79, v167
  v_mov_b32 v80, v168
  v_mov_b32 v81, v169
  v_mov_b32 v82, v170
  v_mov_b32 v83, v171
  v_mov_b32 v84, v172
  v_mov_b32 v85, v173
  v_mov_b32 v86, v174
  v_mov_b32 v87, v175
L_tail_kernel_a_cwd:
  s_waitcnt lgkmcnt(0)
  s_barrier
  s_mul_i32 s26, s46, 36864
  s_mul_i32 s27, s45, 9216
  s_add_u32 s26, s26, s27
  s_add_u32 s26, s26, 87040
  v_add_u32 v4, s26, v11
  ds_read_b128 v[88:91], v4 offset:0
  ds_read_b128 v[92:95], v4 offset:1024
  ds_read_b128 v[96:99], v4 offset:2048
  ds_read_b128 v[100:103], v4 offset:3072
  ds_read_b128 v[104:107], v4 offset:4096
  ds_read_b128 v[108:111], v4 offset:5120
  ds_read_b128 v[112:115], v4 offset:6144
  ds_read_b128 v[116:119], v4 offset:7168
  ds_read_b128 v[120:123], v4 offset:8192
  s_waitcnt lgkmcnt(0)
  v_add_f32 v76, v76, v88
  v_add_f32 v100, v100, v112
  v_add_f32 v77, v77, v89
  v_add_f32 v101, v101, v113
  v_add_f32 v78, v78, v90
  v_add_f32 v102, v102, v114
  v_add_f32 v79, v79, v91
  v_add_f32 v103, v103, v115
  v_add_f32 v80, v80, v92
  v_add_f32 v104, v104, v116
  v_add_f32 v81, v81, v93
  v_add_f32 v105, v105, v117
  v_add_f32 v82, v82, v94
  v_add_f32 v106, v106, v118
  v_add_f32 v83, v83, v95
  v_add_f32 v107, v107, v119
  v_add_f32 v84, v84, v96
  v_add_f32 v108, v108, v120
  v_add_f32 v85, v85, v97
  v_add_f32 v109, v109, v121
  v_add_f32 v86, v86, v98
  v_add_f32 v110, v110, v122
  v_add_f32 v87, v87, v99
  v_add_f32 v111, v111, v123
  v_add_f32 v76, v76, v100
  v_add_f32 v77, v77, v101
  v_add_f32 v78, v78, v102
  v_add_f32 v79, v79, v103
  v_add_f32 v80, v80, v104
  v_add_f32 v81, v81, v105
  v_add_f32 v82, v82, v106
  v_add_f32 v83, v83, v107
  v_add_f32 v84, v84, v108
  v_add_f32 v85, v85, v109
  v_add_f32 v86, v86, v110
  v_add_f32 v87, v87, v111
  v_mov_b32 v4, v84
  v_mov_b32 v5, v84
  s_nop 1
  v_permlane32_swap_b32 v4, v5
  v_mov_b32 v4, v5
  s_cmp_lg_u32 s28, 0
  s_cbranch_scc0 L_tail_kernel_a_chk
  s_barrier
  s_branch L_tail_kernel_a_fin
L_tail_kernel_a_chk:
  v_mov_b32 v6, 0
  v_fma_f32 v6, v76, 0, v6
  v_fma_f32 v6, v77, 0, v6
  v_fma_f32 v6, v78, 0, v6
  v_fma_f32 v6, v79, 0, v6
  v_fma_f32 v6, v80, 0, v6
  v_fma_f32 v6, v81, 0, v6
  v_fma_f32 v6, v82, 0, v6
  v_fma_f32 v6, v83, 0, v6
  v_fma_f32 v6, v84, 0, v6
  v_fma_f32 v6, v85, 0, v6
  v_fma_f32 v6, v86, 0, v6
  v_fma_f32 v6, v87, 0, v6
  v_cmp_u_f32 s[46:47], v6, v6
  v_cmp_gt_f32 vcc, 0x21800000, v4
  s_nop 1
  s_or_b64 s[46:47], s[46:47], vcc
  v_cmp_le_f32 vcc, 0x7b800000, v4
  s_nop 1
  s_or_b64 s[46:47], s[46:47], vcc
  s_cmp_lg_u64 s[46:47], 0
  s_cselect_b32 s46, 1, 0
  v_mov_b32 v6, s46
  v_mov_b32 v7, 160768
  s_lshl_b32 s47, s22, 2
  v_add_u32 v7, s47, v7
  ds_write_b32 v7, v6
  s_waitcnt lgkmcnt(0)
  s_barrier
  v_mov_b32 v7, 160768
  ds_read_b128 v[88:91], v7
  ds_read_b128 v[92:95], v7 offset:16
  s_waitcnt lgkmcnt(0)
  v_or_b32 v88, v88, v89
  v_or_b32 v88, v88, v90
  v_or_b32 v88, v88, v91
  v_or_b32 v88, v88, v92
  v_or_b32 v88, v88, v93
  v_or_b32 v88, v88, v94
  v_or_b32 v88, v88, v95
  s_nop 0
  v_readfirstlane_b32 s46, v88
  s_nop 3
  s_cmp_lg_u32 s46, 0
  s_cbranch_scc1 L_tail_kernel_a_fb
L_tail_kernel_a_fin:
  v_rcp_f32 v4, v4
  s_nop 0
  s_add_u32 s53, s55, 5120
  s_add_u32 s54, s29, 40960
  s_mov_b32 m0, s53
  s_mov_b32 exec_lo, -1
  s_mov_b32 exec_hi, 0xff
  buffer_load_dwordx4 v188, s[56:59], s54 offen lds
  s_mov_b64 exec, -1
  s_add_u32 s53, s53, 5120
  s_add_u32 s54, s54, 40960
  s_mov_b32 m0, s53
  s_mov_b32 exec_lo, -1
  s_mov_b32 exec_hi, 0xff
  buffer_load_dwordx4 v188, s[56:59], s54 offen lds
  s_mov_b64 exec, -1
  s_add_u32 s53, s53, 5120
  s_add_u32 s54, s54, 40960
  s_mov_b32 m0, s53
  s_mov_b32 exec_lo, -1
  s_mov_b32 exec_hi, 0xff
  buffer_load_dwordx4 v188, s[56:59], s54 offen lds
  s_mov_b64 exec, -1
  s_add_u32 s53, s53, 5120
  s_add_u32 s54, s54, 40960
  v_mul_f32 v76, v76, v4
  v_mul_f32 v77, v77, v4
  v_mul_f32 v78, v78, v4
  v_mul_f32 v79, v79, v4
  v_mul_f32 v80, v80, v4
  v_mul_f32 v81, v81, v4
  v_mul_f32 v82, v82, v4
  v_mul_f32 v83, v83, v4
  v_mul_f32 v84, v84, v4
  v_mul_f32 v85, v85, v4
  v_mul_f32 v86, v86, v4
  v_mul_f32 v87, v87, v4
  v_cvt_pk_bf16_f32 v76, v76, v77
  v_cvt_pk_bf16_f32 v77, v78, v79
  v_cvt_pk_bf16_f32 v78, v80, v81
  v_cvt_pk_bf16_f32 v79, v82, v83
  v_cvt_pk_bf16_f32 v80, v84, v85
  v_cvt_pk_bf16_f32 v81, v86, v87
  s_add_u32 s26, s40, s45
  s_mul_i32 s26, s26, 40960
  s_add_u32 s26, s26, 15728640
  s_lshr_b32 s27, s20, 1
  s_mul_i32 s27, s27, 2560
  s_add_u32 s26, s26, s27
  s_mul_i32 s27, s23, 1536
  v_add_u32 v4, s27, v11
  s_lshl_b32 s27, s23, 3
  s_add_u32 s27, s27, 1024
  v_add_u32 v5, s27, v11
  buffer_store_dwordx4 v[76:79], v4, s[8:11], s26 offen sc1
  s_mov_b64 exec, s[32:33]
  buffer_store_dwordx2 v[80:81], v5, s[8:11], s26 offen sc1
  s_mov_b64 exec, -1
  s_waitcnt vmcnt(5)
  s_add_u32 s26, s36, 0
  s_mul_i32 s52, s26, 40960
  s_add_u32 s52, s52, 18350080
  s_cmp_eq_u32 s26, 0
  s_cbranch_scc0 L_tail_kernel_a_wn0
  v_cmp_gt_u32 vcc, 8, v181
  s_nop 1
  v_cndmask_b32 v216, v216, 0, vcc
  v_cndmask_b32 v217, v217, 0, vcc
  v_cndmask_b32 v218, v218, 0, vcc
  v_cndmask_b32 v219, v219, 0, vcc
  v_cndmask_b32 v220, v220, 0, vcc
  v_cndmask_b32 v221, v221, 0, vcc
  v_cndmask_b32 v222, v222, 0, vcc
  v_cndmask_b32 v223, v223, 0, vcc
  v_cmp_gt_u32 vcc, 2, v180
  s_nop 1
  v_cndmask_b32 v224, v224, 0, vcc
  v_cndmask_b32 v225, v225, 0, vcc
  v_cndmask_b32 v226, v226, 0, vcc
  v_cndmask_b32 v227, v227, 0, vcc
  v_cndmask_b32 v228, v228, 0, vcc
  v_cndmask_b32 v229, v229, 0, vcc
  v_cndmask_b32 v230, v230, 0, vcc
  v_cndmask_b32 v231, v231, 0, vcc
  v_mov_b32 v44, v200
  v_mov_b32 v45, v201
  v_mov_b32 v46, v202
  v_mov_b32 v47, v203
  v_mov_b32 v48, v204
  v_mov_b32 v49, v205
  v_mov_b32 v50, v206
  v_mov_b32 v51, v207
  s_branch L_tail_kernel_a_wm0
L_tail_kernel_a_wn0:
  v_mov_b32 v44, v192
  v_mov_b32 v45, v193
  v_mov_b32 v46, v194
  v_mov_b32 v47, v195
  v_mov_b32 v48, v196
  v_mov_b32 v49, v197
  v_mov_b32 v50, v198
  v_mov_b32 v51, v199
L_tail_kernel_a_wm0:
  v_cmp_eq_u32 vcc, 3, v180
  s_nop 1
  v_cndmask_b32 v212, v212, 0, vcc
  v_cndmask_b32 v213, v213, 0, vcc
  v_cndmask_b32 v214, v214, 0, vcc
  v_cndmask_b32 v215, v215, 0, vcc
  v_cmp_eq_u32 vcc, 2, v180
  s_cmp_eq_u32 s37, 0
  s_cbranch_scc0 L_tail_kernel_a_wo0
  v_cndmask_b32 v214, v214, 0, vcc
  v_cndmask_b32 v215, v215, 0, vcc
  s_branch L_tail_kernel_a_wp0
L_tail_kernel_a_wo0:
  v_cndmask_b32 v212, v212, 0, vcc
  v_cndmask_b32 v213, v213, 0, vcc
L_tail_kernel_a_wp0:
  s_nop 1
  v_mfma_f32_16x16x32_bf16 v[44:47], v[216:219], v[212:215], v[44:47]
  v_mfma_f32_16x16x32_bf16 v[48:51], v[220:223], v[212:215], v[48:51]
  s_nop 9
  v_max3_f32 v4, v44, v45, v46
  v_max3_f32 v4, v4, v47, v48
  v_max3_f32 v4, v4, v49, v50
  v_max_f32 v4, v4, v51
  v_mov_b32 v5, v4
  s_nop 1
  v_permlane32_swap_b32 v4, v5
  v_max_f32 v4, v4, v5
  v_mov_b32 v5, v4
  s_nop 1
  v_permlane16_swap_b32 v4, v5
  v_max_f32 v4, v4, v5
  v_sub_f32 v44, v44, v4
  v_sub_f32 v45, v45, v4
  v_sub_f32 v46, v46, v4
  v_sub_f32 v47, v47, v4
  v_sub_f32 v48, v48, v4
  v_sub_f32 v49, v49, v4
  v_sub_f32 v50, v50, v4
  v_sub_f32 v51, v51, v4
  v_exp_f32 v44, v44
  v_exp_f32 v45, v45
  v_exp_f32 v46, v46
  v_exp_f32 v47, v47
  v_exp_f32 v48, v48
  v_exp_f32 v49, v49
  v_exp_f32 v50, v50
  v_exp_f32 v51, v51
  s_nop 0
  v_cvt_pk_bf16_f32 v52, v44, v45
  v_cvt_pk_bf16_f32 v53, v46, v47
  v_cvt_pk_bf16_f32 v54, v48, v49
  v_cvt_pk_bf16_f32 v55, v50, v51
  s_nop 1
  v_mfma_f32_16x16x32_bf16 v[56:59], v[224:227], v[52:55], 0
  v_mfma_f32_16x16x32_bf16 v[60:63], v[228:231], v[52:55], 0
  v_mfma_f32_16x16x32_bf16 v[64:67], v[208:211], v[52:55], 0
  s_nop 9
  v_rcp_f32 v4, v64
  s_nop 0
  v_mul_f32 v56, v56, v4
  v_mul_f32 v57, v57, v4
  v_mul_f32 v58, v58, v4
  v_mul_f32 v59, v59, v4
  v_mul_f32 v60, v60, v4
  v_mul_f32 v61, v61, v4
  v_mul_f32 v62, v62, v4
  v_mul_f32 v63, v63, v4
  v_cvt_pk_bf16_f32 v56, v56, v57
  v_cvt_pk_bf16_f32 v57, v58, v59
  v_cvt_pk_bf16_f32 v58, v60, v61
  v_cvt_pk_bf16_f32 v59, v62, v63
  s_mov_b64 exec, s[32:33]
  buffer_store_dwordx4 v[56:59], v187, s[8:11], s52 offen sc1
  s_mov_b32 exec_lo, 0
  s_mov_b32 exec_hi, 0x0000ffff
  buffer_store_dwordx2 v[56:57], v187, s[8:11], s52 offen sc1
  s_mov_b64 exec, -1
  s_nop 1
  s_add_u32 s26, s36, 1
  s_mul_i32 s52, s26, 40960
  s_add_u32 s52, s52, 18350080
  s_cmp_eq_u32 s26, 0
  s_cbranch_scc0 L_tail_kernel_a_wn1
  v_cmp_gt_u32 vcc, 8, v181
  s_nop 1
  v_cndmask_b32 v236, v236, 0, vcc
  v_cndmask_b32 v237, v237, 0, vcc
  v_cndmask_b32 v238, v238, 0, vcc
  v_cndmask_b32 v239, v239, 0, vcc
  v_cndmask_b32 v240, v240, 0, vcc
  v_cndmask_b32 v241, v241, 0, vcc
  v_cndmask_b32 v242, v242, 0, vcc
  v_cndmask_b32 v243, v243, 0, vcc
  v_cmp_gt_u32 vcc, 2, v180
  s_nop 1
  v_cndmask_b32 v244, v244, 0, vcc
  v_cndmask_b32 v245, v245, 0, vcc
  v_cndmask_b32 v246, v246, 0, vcc
  v_cndmask_b32 v247, v247, 0, vcc
  v_cndmask_b32 v248, v248, 0, vcc
  v_cndmask_b32 v249, v249, 0, vcc
  v_cndmask_b32 v250, v250, 0, vcc
  v_cndmask_b32 v251, v251, 0, vcc
  v_mov_b32 v44, v200
  v_mov_b32 v45, v201
  v_mov_b32 v46, v202
  v_mov_b32 v47, v203
  v_mov_b32 v48, v204
  v_mov_b32 v49, v205
  v_mov_b32 v50, v206
  v_mov_b32 v51, v207
  s_branch L_tail_kernel_a_wm1
L_tail_kernel_a_wn1:
L_tail_kernel_a_wm1:
  v_cmp_eq_u32 vcc, 3, v180
  s_nop 1
  v_cndmask_b32 v232, v232, 0, vcc
  v_cndmask_b32 v233, v233, 0, vcc
  v_cndmask_b32 v234, v234, 0, vcc
  v_cndmask_b32 v235, v235, 0, vcc
  v_cmp_eq_u32 vcc, 2, v180
  s_cmp_eq_u32 s37, 0
  s_cbranch_scc0 L_tail_kernel_a_wo1
  v_cndmask_b32 v234, v234, 0, vcc
  v_cndmask_b32 v235, v235, 0, vcc
  s_branch L_tail_kernel_a_wp1
L_tail_kernel_a_wo1:
  v_cndmask_b32 v232, v232, 0, vcc
  v_cndmask_b32 v233, v233, 0, vcc
L_tail_kernel_a_wp1:
  s_nop 1
  v_mfma_f32_16x16x32_bf16 v[44:47], v[236:239], v[232:235], v[192:195]
  v_mfma_f32_16x16x32_bf16 v[48:51], v[240:243], v[232:235], v[196:199]
  s_nop 9
  v_max3_f32 v4, v44, v45, v46
  v_max3_f32 v4, v4, v47, v48
  v_max3_f32 v4, v4, v49, v50
  v_max_f32 v4, v4, v51
  v_mov_b32 v5, v4
  s_nop 1
  v_permlane32_swap_b32 v4, v5
  v_max_f32 v4, v4, v5
  v_mov_b32 v5, v4
  s_nop 1
  v_permlane16_swap_b32 v4, v5
  v_max_f32 v4, v4, v5
  v_sub_f32 v44, v44, v4
  v_sub_f32 v45, v45, v4
  v_sub_f32 v46, v46, v4
  v_sub_f32 v47, v47, v4
  v_sub_f32 v48, v48, v4
  v_sub_f32 v49, v49, v4
  v_sub_f32 v50, v50, v4
  v_sub_f32 v51, v51, v4
  v_exp_f32 v44, v44
  v_exp_f32 v45, v45
  v_exp_f32 v46, v46
  v_exp_f32 v47, v47
  v_exp_f32 v48, v48
  v_exp_f32 v49, v49
  v_exp_f32 v50, v50
  v_exp_f32 v51, v51
  s_nop 0
  v_cvt_pk_bf16_f32 v52, v44, v45
  v_cvt_pk_bf16_f32 v53, v46, v47
  v_cvt_pk_bf16_f32 v54, v48, v49
  v_cvt_pk_bf16_f32 v55, v50, v51
  s_nop 1
  v_mfma_f32_16x16x32_bf16 v[56:59], v[244:247], v[52:55], 0
  v_mfma_f32_16x16x32_bf16 v[60:63], v[248:251], v[52:55], 0
  v_mfma_f32_16x16x32_bf16 v[64:67], v[208:211], v[52:55], 0
  s_nop 9
  v_rcp_f32 v4, v64
  s_nop 0
  v_mul_f32 v56, v56, v4
  v_mul_f32 v57, v57, v4
  v_mul_f32 v58, v58, v4
  v_mul_f32 v59, v59, v4
  v_mul_f32 v60, v60, v4
  v_mul_f32 v61, v61, v4
  v_mul_f32 v62, v62, v4
  v_mul_f32 v63, v63, v4
  v_cvt_pk_bf16_f32 v56, v56, v57
  v_cvt_pk_bf16_f32 v57, v58, v59
  v_cvt_pk_bf16_f32 v58, v60, v61
  v_cvt_pk_bf16_f32 v59, v62, v63
  s_mov_b64 exec, s[32:33]
  buffer_store_dwordx4 v[56:59], v187, s[8:11], s52 offen sc1
  s_mov_b32 exec_lo, 0
  s_mov_b32 exec_hi, 0x0000ffff
  buffer_store_dwordx2 v[56:57], v187, s[8:11], s52 offen sc1
  s_mov_b64 exec, -1
  s_nop 1
  s_branch L_tail_kernel_a_end
L_tail_kernel_a_fb:
  s_waitcnt vmcnt(0)
  s_mov_b32 s28, 1
  s_mov_b32 s42, s24
  s_mov_b32 s44, 16
  v_mov_b32 v108, 0xff7fffff
  v_mov_b32 v109, 0xff7fffff
  v_mov_b32 v110, 0xff7fffff
  v_mov_b32 v111, 0xff7fffff
L_tail_kernel_a_fbl:
  buffer_load_dwordx4 v[44:47], v8, s[8:11], s42 offen sc1
  s_mov_b64 exec, s[32:33]
  buffer_load_dwordx2 v[48:49], v9, s[8:11], s42 offen sc1
  s_mov_b64 exec, -1
  s_waitcnt vmcnt(0)
  v_mfma_f32_32x32x16_bf16 v[76:91], v[44:47], v[12:15], 0
  v_mfma_f32_32x32x8_bf16 v[76:91], v[48:49], v[16:17], v[76:91]
  s_nop 7
  s_nop 7
  v_max3_f32 v108, v108, v76, v77
  v_max3_f32 v108, v108, v78, v79
  v_max3_f32 v108, v108, v80, v81
  v_max3_f32 v108, v108, v82, v83
  v_max3_f32 v108, v108, v84, v85
  v_max3_f32 v108, v108, v86, v87
  v_max3_f32 v108, v108, v88, v89
  v_max3_f32 v108, v108, v90, v91
  v_mfma_f32_32x32x16_bf16 v[76:91], v[44:47], v[20:23], 0
  v_mfma_f32_32x32x8_bf16 v[76:91], v[48:49], v[24:25], v[76:91]
  s_nop 7
  s_nop 7
  v_max3_f32 v109, v109, v76, v77
  v_max3_f32 v109, v109, v78, v79
  v_max3_f32 v109, v109, v80, v81
  v_max3_f32 v109, v109, v82, v83
  v_max3_f32 v109, v109, v84, v85
  v_max3_f32 v109, v109, v86, v87
  v_max3_f32 v109, v109, v88, v89
  v_max3_f32 v109, v109, v90, v91
  v_mfma_f32_32x32x16_bf16 v[76:91], v[44:47], v[28:31], 0
  v_mfma_f32_32x32x8_bf16 v[76:91], v[48:49], v[32:33], v[76:91]
  s_nop 7
  s_nop 7
  v_max3_f32 v110, v110, v76, v77
  v_max3_f32 v110, v110, v78, v79
  v_max3_f32 v110, v110, v80, v81
  v_max3_f32 v110, v110, v82, v83
  v_max3_f32 v110, v110, v84, v85
  v_max3_f32 v110, v110, v86, v87
  v_max3_f32 v110, v110, v88, v89
  v_max3_f32 v110, v110, v90, v91
  v_mfma_f32_32x32x16_bf16 v[76:91], v[44:47], v[36:39], 0
  v_mfma_f32_32x32x8_bf16 v[76:91], v[48:49], v[40:41], v[76:91]
  s_nop 7
  s_nop 7
  v_max3_f32 v111, v111, v76, v77
  v_max3_f32 v111, v111, v78, v79
  v_max3_f32 v111, v111, v80, v81
  v_max3_f32 v111, v111, v82, v83
  v_max3_f32 v111, v111, v84, v85
  v_max3_f32 v111, v111, v86, v87
  v_max3_f32 v111, v111, v88, v89
  v_max3_f32 v111, v111, v90, v91
  s_add_u32 s42, s42, 2560
  s_sub_u32 s44, s44, 1
  s_cmp_lg_u32 s44, 0
  s_cbranch_scc1 L_tail_kernel_a_fbl
  v_mov_b32 v4, v108
  s_nop 1
  v_permlane32_swap_b32 v108, v4
  v_max_f32 v108, v108, v4
  v_mov_b32 v4, v109
  s_nop 1
  v_permlane32_swap_b32 v109, v4
  v_max_f32 v109, v109, v4
  v_mov_b32 v4, v110
  s_nop 1
  v_permlane32_swap_b32 v110, v4
  v_max_f32 v110, v110, v4
  v_mov_b32 v4, v111
  s_nop 1
  v_permlane32_swap_b32 v111, v4
  v_max_f32 v111, v111, v4
  s_barrier
  v_lshlrev_b32 v4, 2, v1
  s_lshl_b32 s46, s22, 10
  s_add_u32 s46, s46, 87040
  v_add_u32 v5, s46, v4
  ds_write_b32 v5, v108 offset:0
  ds_write_b32 v5, v109 offset:256
  ds_write_b32 v5, v110 offset:512
  ds_write_b32 v5, v111 offset:768
  s_waitcnt lgkmcnt(0)
  s_barrier
  s_lshr_b32 s46, s22, 2
  s_lshl_b32 s46, s46, 12
  s_add_u32 s46, s46, 87040
  v_add_u32 v5, s46, v4
  ds_read_b32 v76, v5 offset:0
  ds_read_b32 v77, v5 offset:1024
  ds_read_b32 v78, v5 offset:2048
  ds_read_b32 v79, v5 offset:3072
  ds_read_b32 v80, v5 offset:256
  ds_read_b32 v81, v5 offset:1280
  ds_read_b32 v82, v5 offset:2304
  ds_read_b32 v83, v5 offset:3328
  ds_read_b32 v84, v5 offset:512
  ds_read_b32 v85, v5 offset:1536
  ds_read_b32 v86, v5 offset:2560
  ds_read_b32 v87, v5 offset:3584
  ds_read_b32 v88, v5 offset:768
  ds_read_b32 v89, v5 offset:1792
  ds_read_b32 v90, v5 offset:2816
  ds_read_b32 v91, v5 offset:3840
  s_waitcnt lgkmcnt(0)
  s_barrier
  v_cmp_lt_u32 vcc, 31, v1
  v_max3_f32 v76, v76, v77, v78
  v_max_f32 v76, v76, v79
  v_sub_f32 v76, 0, v76
  v_and_b32 v77, 0xffff0000, v76
  v_sub_f32 v76, v76, v77
  v_and_b32 v78, 0xffff0000, v76
  v_sub_f32 v76, v76, v78
  v_lshrrev_b32 v77, 16, v77
  v_or_b32 v77, v77, v78
  v_lshrrev_b32 v76, 16, v76
  v_cndmask_b32 v16, v16, v77, vcc
  v_cndmask_b32 v17, v17, v76, vcc
  v_max3_f32 v80, v80, v81, v82
  v_max_f32 v80, v80, v83
  v_sub_f32 v80, 0, v80
  v_and_b32 v81, 0xffff0000, v80
  v_sub_f32 v80, v80, v81
  v_and_b32 v82, 0xffff0000, v80
  v_sub_f32 v80, v80, v82
  v_lshrrev_b32 v81, 16, v81
  v_or_b32 v81, v81, v82
  v_lshrrev_b32 v80, 16, v80
  v_cndmask_b32 v24, v24, v81, vcc
  v_cndmask_b32 v25, v25, v80, vcc
  v_max3_f32 v84, v84, v85, v86
  v_max_f32 v84, v84, v87
  v_sub_f32 v84, 0, v84
  v_and_b32 v85, 0xffff0000, v84
  v_sub_f32 v84, v84, v85
  v_and_b32 v86, 0xffff0000, v84
  v_sub_f32 v84, v84, v86
  v_lshrrev_b32 v85, 16, v85
  v_or_b32 v85, v85, v86
  v_lshrrev_b32 v84, 16, v84
  v_cndmask_b32 v32, v32, v85, vcc
  v_cndmask_b32 v33, v33, v84, vcc
  v_max3_f32 v88, v88, v89, v90
  v_max_f32 v88, v88, v91
  v_sub_f32 v88, 0, v88
  v_and_b32 v89, 0xffff0000, v88
  v_sub_f32 v88, v88, v89
  v_and_b32 v90, 0xffff0000, v88
  v_sub_f32 v88, v88, v90
  v_lshrrev_b32 v89, 16, v89
  v_or_b32 v89, v89, v90
  v_lshrrev_b32 v88, 16, v88
  v_cndmask_b32 v40, v40, v89, vcc
  v_cndmask_b32 v41, v41, v88, vcc
  s_branch L_tail_kernel_a_main
L_tail_kernel_a_end:
  s_lshr_b32 s3, s2, 5
  s_lshl_b32 s3, s3, 1
  v_add_u32 v3, s3, v0
  v_mul_u32_u24 v3, 256, v3
  s_and_b32 s3, s2, 31
  s_lshl_b32 s3, s3, 2
  s_add_u32 s3, s3, 8192
  v_add_u32 v3, s3, v3
  s_and_b32 s3, s2, 7
  s_lshl_b32 s3, s3, 1
  s_add_u32 s3, s3, 14
  v_add_u32 v4, s3, v0
  v_mul_u32_u24 v4, 256, v4
  s_lshr_b32 s3, s2, 3
  s_lshl_b32 s3, s3, 2
  s_add_u32 s3, s3, 8192
  v_add_u32 v4, s3, v4
  v_cmp_gt_u32 vcc, 2, v0
  v_mov_b32 v2, s60
  s_nop 0
  v_cndmask_b32 v3, v4, v3, vcc
  v_cmp_gt_u32 vcc, 4, v0
  s_nop 1
  s_and_b64 vcc, vcc, 5
  s_waitcnt vmcnt(0)
  s_barrier
  s_and_saveexec_b64 s[62:63], vcc
  buffer_store_dword v2, v3, s[64:67], 0 offen sc1
  s_mov_b64 exec, s[62:63]
  s_load_dwordx2 s[4:5], s[0:1], 16
  s_load_dwordx2 s[6:7], s[0:1], 40
  s_load_dwordx2 s[28:29], s[0:1], 48
  s_load_dwordx2 s[30:31], s[0:1], 64
  s_and_b32 s24, s2, 7
  s_lshr_b32 s25, s2, 3
  s_lshr_b32 s20, s24, 2
  s_and_b32 s21, s24, 3
  s_lshl_b32 s21, s21, 2
  s_and_b32 s3, s25, 3
  s_add_u32 s21, s21, s3
  s_lshr_b32 s22, s25, 2
  v_and_b32 v1, 63, v0
  v_lshrrev_b32 v4, 6, v0
  v_and_b32 v2, 15, v1
  v_readfirstlane_b32 s23, v4
  v_lshrrev_b32 v3, 4, v1
  s_waitcnt lgkmcnt(0)
  s_cmp_eq_u32 s20, 0
  s_cselect_b32 s4, s4, s6
  s_cselect_b32 s5, s5, s7
  s_mov_b32 s8, s4
  s_and_b32 s9, s5, 0xffff
  s_mov_b32 s10, 819200
  s_mov_b32 s11, 0x20000
  s_mov_b32 s12, s30
  s_and_b32 s13, s31, 0xffff
  s_mov_b32 s14, 20971520
  s_mov_b32 s15, 0x20000
  s_mov_b32 s16, s28
  s_and_b32 s17, s29, 0xffff
  s_mov_b32 s18, 5242880
  s_mov_b32 s19, 0x20000
  s_lshr_b32 s24, s23, 1
  s_lshl_b32 s3, s21, 2
  s_add_u32 s24, s24, s3
  s_mul_i32 s26, s24, 40960
  s_mul_i32 s3, s20, 2621440
  s_add_u32 s26, s26, s3
  s_add_u32 s26, s26, 15728640
  s_and_b32 s3, s23, 1
  s_lshl_b32 s3, s3, 8
  v_lshlrev_b32 v4, 9, v3
  v_lshl_add_u32 v4, v2, 4, v4
  v_add_u32 v13, s3, v4
  v_bfe_u32 v4, v1, 2, 2
  v_lshrrev_b32 v5, 1, v3
  v_lshl_add_u32 v4, v5, 4, v4
  v_and_b32 v5, 1, v3
  v_lshl_add_u32 v4, v5, 2, v4
  v_mul_u32_u24 v4, 160, v4
  v_and_b32 v5, 3, v1
  v_lshl_add_u32 v14, v5, 3, v4
  v_add_u32 v15, 51200, v14
  v_mov_b32 v136, 0
  v_mov_b32 v137, 0
  v_mov_b32 v138, 0
  v_mov_b32 v139, 0
  v_mov_b32 v140, 0
  v_mov_b32 v141, 0
  v_mov_b32 v142, 0
  v_mov_b32 v143, 0
  v_mov_b32 v144, 0
  v_mov_b32 v145, 0
  v_mov_b32 v146, 0
  v_mov_b32 v147, 0
  v_mov_b32 v148, 0
  v_mov_b32 v149, 0
  v_mov_b32 v150, 0
  v_mov_b32 v151, 0
  v_mov_b32 v152, 0
  v_mov_b32 v153, 0
  v_mov_b32 v154, 0
  v_mov_b32 v155, 0
  ds_read_b64_tr_b16 v[96:97], v14 offset:0
  ds_read_b64_tr_b16 v[98:99], v14 offset:1280
  ds_read_b64_tr_b16 v[100:101], v14 offset:32
  ds_read_b64_tr_b16 v[102:103], v14 offset:1312
  ds_read_b64_tr_b16 v[104:105], v14 offset:64
  ds_read_b64_tr_b16 v[106:107], v14 offset:1344
  ds_read_b64_tr_b16 v[108:109], v14 offset:96
  ds_read_b64_tr_b16 v[110:111], v14 offset:1376
  ds_read_b64_tr_b16 v[112:113], v14 offset:128
  ds_read_b64_tr_b16 v[114:115], v14 offset:1408
  s_mul_i32 s24, s23, 2816
  s_add_u32 s24, s24, 102400
  v_mul_u32_u24 v160, 176, v2
  v_lshl_add_u32 v160, v3, 3, v160
  v_add_u32 v160, s24, v160
  s_and_b32 s3, s23, 1
  s_lshr_b32 s37, s23, 1
  s_lshl_b32 s27, s21, 2
  s_add_u32 s37, s37, s27
  s_lshl_b32 s37, s37, 5
  s_cmp_eq_u32 s20, 0
  s_cselect_b32 s27, 4, 0
  s_cselect_b32 s36, 0, 1
  s_lshl_b32 s3, s3, s27
  s_add_u32 s37, s37, s3
  s_mul_i32 s3, s20, 1280
  s_mul_i32 s27, s22, 160
  s_add_u32 s35, s3, s27
  v_add_u32 v5, 0, v1
  v_mul_u32_u24 v6, 6554, v5
  v_lshrrev_b32 v6, 16, v6
  v_mul_u32_u24 v7, 10, v6
  v_sub_u32 v5, v5, v7
  v_mul_u32_u24 v7, 176, v6
  v_lshl_add_u32 v7, v5, 4, v7
  v_add_u32 v161, s24, v7
  v_lshlrev_b32 v6, s36, v6
  v_add_u32 v6, s37, v6
  v_mul_u32_u24 v6, 2560, v6
  v_lshl_add_u32 v164, v5, 4, v6
  v_add_u32 v5, 64, v1
  v_mul_u32_u24 v6, 6554, v5
  v_lshrrev_b32 v6, 16, v6
  v_mul_u32_u24 v7, 10, v6
  v_sub_u32 v5, v5, v7
  v_mul_u32_u24 v7, 176, v6
  v_lshl_add_u32 v7, v5, 4, v7
  v_add_u32 v162, s24, v7
  v_lshlrev_b32 v6, s36, v6
  v_add_u32 v6, s37, v6
  v_mul_u32_u24 v6, 2560, v6
  v_lshl_add_u32 v165, v5, 4, v6
  v_add_u32 v5, 128, v1
  v_mul_u32_u24 v6, 6554, v5
  v_lshrrev_b32 v6, 16, v6
  v_mul_u32_u24 v7, 10, v6
  v_sub_u32 v5, v5, v7
  v_mul_u32_u24 v7, 176, v6
  v_lshl_add_u32 v7, v5, 4, v7
  v_add_u32 v163, s24, v7
  v_lshlrev_b32 v6, s36, v6
  v_add_u32 v6, s37, v6
  v_mul_u32_u24 v6, 2560, v6
  v_lshl_add_u32 v166, v5, 4, v6
  v_and_b32 v187, 31, v0
  v_lshlrev_b32 v187, 2, v187
  s_lshl_b32 s3, s20, 4
  s_and_b32 s62, s21, 14
  s_add_u32 s62, s62, s3
  s_mul_i32 s62, s62, 256
  s_add_u32 s62, s62, 8192
  v_readfirstlane_b32 s3, v0
  s_cmp_ge_u32 s3, 64
  s_cbranch_scc1 L_tail_kernel_p2_pd
  s_mov_b32 s61, 50000
  buffer_load_dword v188, v187, s[64:67], s62 offen sc1
  s_sleep 2
  buffer_load_dword v189, v187, s[64:67], s62 offen sc1
  s_sleep 2
L_tail_kernel_p2_pl:
  buffer_load_dword v190, v187, s[64:67], s62 offen sc1
  s_waitcnt vmcnt(2)
  v_cmp_ne_u32 vcc, s60, v188
  s_nop 1
  s_cmp_eq_u64 vcc, 0
  s_cbranch_scc1 L_tail_kernel_p2_pw
  s_sleep 2
  buffer_load_dword v188, v187, s[64:67], s62 offen sc1
  s_waitcnt vmcnt(2)
  v_cmp_ne_u32 vcc, s60, v189
  s_nop 1
  s_cmp_eq_u64 vcc, 0
  s_cbranch_scc1 L_tail_kernel_p2_pw
  s_sleep 2
  buffer_load_dword v189, v187, s[64:67], s62 offen sc1
  s_waitcnt vmcnt(2)
  v_cmp_ne_u32 vcc, s60, v190
  s_nop 1
  s_cmp_eq_u64 vcc, 0
  s_cbranch_scc1 L_tail_kernel_p2_pw
  s_sleep 2
  s_sub_u32 s61, s61, 1
  s_cmp_lg_u32 s61, 0
  s_cbranch_scc1 L_tail_kernel_p2_pl
L_tail_kernel_p2_pw:
L_tail_kernel_p2_pd:
  s_barrier
  s_add_u32 s24, s26, 0
  buffer_load_dwordx4 v[16:19], v13, s[12:15], s24 offen sc1
  s_add_u32 s24, s26, 2048
  buffer_load_dwordx4 v[20:23], v13, s[12:15], s24 offen sc1
  s_add_u32 s24, s26, 4096
  buffer_load_dwordx4 v[24:27], v13, s[12:15], s24 offen sc1
  s_add_u32 s24, s26, 6144
  buffer_load_dwordx4 v[28:31], v13, s[12:15], s24 offen sc1
  s_add_u32 s24, s26, 8192
  buffer_load_dwordx4 v[32:35], v13, s[12:15], s24 offen sc1
  s_add_u32 s24, s26, 10240
  buffer_load_dwordx4 v[36:39], v13, s[12:15], s24 offen sc1
  s_add_u32 s24, s26, 12288
  buffer_load_dwordx4 v[40:43], v13, s[12:15], s24 offen sc1
  s_add_u32 s24, s26, 14336
  buffer_load_dwordx4 v[44:47], v13, s[12:15], s24 offen sc1
  s_add_u32 s24, s26, 16384
  buffer_load_dwordx4 v[48:51], v13, s[12:15], s24 offen sc1
  s_add_u32 s24, s26, 18432
  buffer_load_dwordx4 v[52:55], v13, s[12:15], s24 offen sc1
  s_add_u32 s24, s26, 20480
  buffer_load_dwordx4 v[56:59], v13, s[12:15], s24 offen sc1
  s_add_u32 s24, s26, 22528
  buffer_load_dwordx4 v[60:63], v13, s[12:15], s24 offen sc1
  s_add_u32 s24, s26, 24576
  buffer_load_dwordx4 v[64:67], v13, s[12:15], s24 offen sc1
  s_add_u32 s24, s26, 26624
  buffer_load_dwordx4 v[68:71], v13, s[12:15], s24 offen sc1
  s_add_u32 s24, s26, 28672
  buffer_load_dwordx4 v[72:75], v13, s[12:15], s24 offen sc1
  s_add_u32 s24, s26, 30720
  buffer_load_dwordx4 v[76:79], v13, s[12:15], s24 offen sc1
  s_add_u32 s24, s26, 32768
  buffer_load_dwordx4 v[80:83], v13, s[12:15], s24 offen sc1
  s_add_u32 s24, s26, 34816
  buffer_load_dwordx4 v[84:87], v13, s[12:15], s24 offen sc1
  s_add_u32 s24, s26, 36864
  buffer_load_dwordx4 v[88:91], v13, s[12:15], s24 offen sc1
  s_add_u32 s24, s26, 38912
  buffer_load_dwordx4 v[92:95], v13, s[12:15], s24 offen sc1
  ds_read_b64_tr_b16 v[116:117], v14 offset:5120
  ds_read_b64_tr_b16 v[118:119], v14 offset:6400
  ds_read_b64_tr_b16 v[120:121], v14 offset:5152
  ds_read_b64_tr_b16 v[122:123], v14 offset:6432
  ds_read_b64_tr_b16 v[124:125], v14 offset:5184
  ds_read_b64_tr_b16 v[126:127], v14 offset:6464
  ds_read_b64_tr_b16 v[128:129], v14 offset:5216
  ds_read_b64_tr_b16 v[130:131], v14 offset:6496
  ds_read_b64_tr_b16 v[132:133], v14 offset:5248
  ds_read_b64_tr_b16 v[134:135], v14 offset:6528
  s_waitcnt vmcnt(19) lgkmcnt(10)
  v_mfma_f32_16x16x32_bf16 v[136:139], v[96:99], v[16:19], v[136:139]
  v_mfma_f32_16x16x32_bf16 v[140:143], v[100:103], v[16:19], v[140:143]
  v_mfma_f32_16x16x32_bf16 v[144:147], v[104:107], v[16:19], v[144:147]
  v_mfma_f32_16x16x32_bf16 v[148:151], v[108:111], v[16:19], v[148:151]
  v_mfma_f32_16x16x32_bf16 v[152:155], v[112:115], v[16:19], v[152:155]
  ds_read_b64_tr_b16 v[96:97], v14 offset:10240
  ds_read_b64_tr_b16 v[98:99], v14 offset:11520
  ds_read_b64_tr_b16 v[100:101], v14 offset:10272
  ds_read_b64_tr_b16 v[102:103], v14 offset:11552
  ds_read_b64_tr_b16 v[104:105], v14 offset:10304
  ds_read_b64_tr_b16 v[106:107], v14 offset:11584
  ds_read_b64_tr_b16 v[108:109], v14 offset:10336
  ds_read_b64_tr_b16 v[110:111], v14 offset:11616
  ds_read_b64_tr_b16 v[112:113], v14 offset:10368
  ds_read_b64_tr_b16 v[114:115], v14 offset:11648
  s_waitcnt vmcnt(18) lgkmcnt(10)
  v_mfma_f32_16x16x32_bf16 v[136:139], v[116:119], v[20:23], v[136:139]
  v_mfma_f32_16x16x32_bf16 v[140:143], v[120:123], v[20:23], v[140:143]
  v_mfma_f32_16x16x32_bf16 v[144:147], v[124:127], v[20:23], v[144:147]
  v_mfma_f32_16x16x32_bf16 v[148:151], v[128:131], v[20:23], v[148:151]
  v_mfma_f32_16x16x32_bf16 v[152:155], v[132:135], v[20:23], v[152:155]
  ds_read_b64_tr_b16 v[116:117], v14 offset:15360
  ds_read_b64_tr_b16 v[118:119], v14 offset:16640
  ds_read_b64_tr_b16 v[120:121], v14 offset:15392
  ds_read_b64_tr_b16 v[122:123], v14 offset:16672
  ds_read_b64_tr_b16 v[124:125], v14 offset:15424
  ds_read_b64_tr_b16 v[126:127], v14 offset:16704
  ds_read_b64_tr_b16 v[128:129], v14 offset:15456
  ds_read_b64_tr_b16 v[130:131], v14 offset:16736
  ds_read_b64_tr_b16 v[132:133], v14 offset:15488
  ds_read_b64_tr_b16 v[134:135], v14 offset:16768
  s_waitcnt vmcnt(17) lgkmcnt(10)
  v_mfma_f32_16x16x32_bf16 v[136:139], v[96:99], v[24:27], v[136:139]
  v_mfma_f32_16x16x32_bf16 v[140:143], v[100:103], v[24:27], v[140:143]
  v_mfma_f32_16x16x32_bf16 v[144:147], v[104:107], v[24:27], v[144:147]
  v_mfma_f32_16x16x32_bf16 v[148:151], v[108:111], v[24:27], v[148:151]
  v_mfma_f32_16x16x32_bf16 v[152:155], v[112:115], v[24:27], v[152:155]
  ds_read_b64_tr_b16 v[96:97], v14 offset:20480
  ds_read_b64_tr_b16 v[98:99], v14 offset:21760
  ds_read_b64_tr_b16 v[100:101], v14 offset:20512
  ds_read_b64_tr_b16 v[102:103], v14 offset:21792
  ds_read_b64_tr_b16 v[104:105], v14 offset:20544
  ds_read_b64_tr_b16 v[106:107], v14 offset:21824
  ds_read_b64_tr_b16 v[108:109], v14 offset:20576
  ds_read_b64_tr_b16 v[110:111], v14 offset:21856
  ds_read_b64_tr_b16 v[112:113], v14 offset:20608
  ds_read_b64_tr_b16 v[114:115], v14 offset:21888
  s_waitcnt vmcnt(16) lgkmcnt(10)
  v_mfma_f32_16x16x32_bf16 v[136:139], v[116:119], v[28:31], v[136:139]
  v_mfma_f32_16x16x32_bf16 v[140:143], v[120:123], v[28:31], v[140:143]
  v_mfma_f32_16x16x32_bf16 v[144:147], v[124:127], v[28:31], v[144:147]
  v_mfma_f32_16x16x32_bf16 v[148:151], v[128:131], v[28:31], v[148:151]
  v_mfma_f32_16x16x32_bf16 v[152:155], v[132:135], v[28:31], v[152:155]
  ds_read_b64_tr_b16 v[116:117], v14 offset:25600
  ds_read_b64_tr_b16 v[118:119], v14 offset:26880
  ds_read_b64_tr_b16 v[120:121], v14 offset:25632
  ds_read_b64_tr_b16 v[122:123], v14 offset:26912
  ds_read_b64_tr_b16 v[124:125], v14 offset:25664
  ds_read_b64_tr_b16 v[126:127], v14 offset:26944
  ds_read_b64_tr_b16 v[128:129], v14 offset:25696
  ds_read_b64_tr_b16 v[130:131], v14 offset:26976
  ds_read_b64_tr_b16 v[132:133], v14 offset:25728
  ds_read_b64_tr_b16 v[134:135], v14 offset:27008
  s_waitcnt vmcnt(15) lgkmcnt(10)
  v_mfma_f32_16x16x32_bf16 v[136:139], v[96:99], v[32:35], v[136:139]
  v_mfma_f32_16x16x32_bf16 v[140:143], v[100:103], v[32:35], v[140:143]
  v_mfma_f32_16x16x32_bf16 v[144:147], v[104:107], v[32:35], v[144:147]
  v_mfma_f32_16x16x32_bf16 v[148:151], v[108:111], v[32:35], v[148:151]
  v_mfma_f32_16x16x32_bf16 v[152:155], v[112:115], v[32:35], v[152:155]
  ds_read_b64_tr_b16 v[96:97], v14 offset:30720
  ds_read_b64_tr_b16 v[98:99], v14 offset:32000
  ds_read_b64_tr_b16 v[100:101], v14 offset:30752
  ds_read_b64_tr_b16 v[102:103], v14 offset:32032
  ds_read_b64_tr_b16 v[104:105], v14 offset:30784
  ds_read_b64_tr_b16 v[106:107], v14 offset:32064
  ds_read_b64_tr_b16 v[108:109], v14 offset:30816
  ds_read_b64_tr_b16 v[110:111], v14 offset:32096
  ds_read_b64_tr_b16 v[112:113], v14 offset:30848
  ds_read_b64_tr_b16 v[114:115], v14 offset:32128
  s_waitcnt vmcnt(14) lgkmcnt(10)
  v_mfma_f32_16x16x32_bf16 v[136:139], v[116:119], v[36:39], v[136:139]
  v_mfma_f32_16x16x32_bf16 v[140:143], v[120:123], v[36:39], v[140:143]
  v_mfma_f32_16x16x32_bf16 v[144:147], v[124:127], v[36:39], v[144:147]
  v_mfma_f32_16x16x32_bf16 v[148:151], v[128:131], v[36:39], v[148:151]
  v_mfma_f32_16x16x32_bf16 v[152:155], v[132:135], v[36:39], v[152:155]
  ds_read_b64_tr_b16 v[116:117], v14 offset:35840
  ds_read_b64_tr_b16 v[118:119], v14 offset:37120
  ds_read_b64_tr_b16 v[120:121], v14 offset:35872
  ds_read_b64_tr_b16 v[122:123], v14 offset:37152
  ds_read_b64_tr_b16 v[124:125], v14 offset:35904
  ds_read_b64_tr_b16 v[126:127], v14 offset:37184
  ds_read_b64_tr_b16 v[128:129], v14 offset:35936
  ds_read_b64_tr_b16 v[130:131], v14 offset:37216
  ds_read_b64_tr_b16 v[132:133], v14 offset:35968
  ds_read_b64_tr_b16 v[134:135], v14 offset:37248
  s_waitcnt vmcnt(13) lgkmcnt(10)
  v_mfma_f32_16x16x32_bf16 v[136:139], v[96:99], v[40:43], v[136:139]
  v_mfma_f32_16x16x32_bf16 v[140:143], v[100:103], v[40:43], v[140:143]
  v_mfma_f32_16x16x32_bf16 v[144:147], v[104:107], v[40:43], v[144:147]
  v_mfma_f32_16x16x32_bf16 v[148:151], v[108:111], v[40:43], v[148:151]
  v_mfma_f32_16x16x32_bf16 v[152:155], v[112:115], v[40:43], v[152:155]
  ds_read_b64_tr_b16 v[96:97], v14 offset:40960
  ds_read_b64_tr_b16 v[98:99], v14 offset:42240
  ds_read_b64_tr_b16 v[100:101], v14 offset:40992
  ds_read_b64_tr_b16 v[102:103], v14 offset:42272
  ds_read_b64_tr_b16 v[104:105], v14 offset:41024
  ds_read_b64_tr_b16 v[106:107], v14 offset:42304
  ds_read_b64_tr_b16 v[108:109], v14 offset:41056
  ds_read_b64_tr_b16 v[110:111], v14 offset:42336
  ds_read_b64_tr_b16 v[112:113], v14 offset:41088
  ds_read_b64_tr_b16 v[114:115], v14 offset:42368
  s_waitcnt vmcnt(12) lgkmcnt(10)
  v_mfma_f32_16x16x32_bf16 v[136:139], v[116:119], v[44:47], v[136:139]
  v_mfma_f32_16x16x32_bf16 v[140:143], v[120:123], v[44:47], v[140:143]
  v_mfma_f32_16x16x32_bf16 v[144:147], v[124:127], v[44:47], v[144:147]
  v_mfma_f32_16x16x32_bf16 v[148:151], v[128:131], v[44:47], v[148:151]
  v_mfma_f32_16x16x32_bf16 v[152:155], v[132:135], v[44:47], v[152:155]
  ds_read_b64_tr_b16 v[116:117], v14 offset:46080
  ds_read_b64_tr_b16 v[118:119], v14 offset:47360
  ds_read_b64_tr_b16 v[120:121], v14 offset:46112
  ds_read_b64_tr_b16 v[122:123], v14 offset:47392
  ds_read_b64_tr_b16 v[124:125], v14 offset:46144
  ds_read_b64_tr_b16 v[126:127], v14 offset:47424
  ds_read_b64_tr_b16 v[128:129], v14 offset:46176
  ds_read_b64_tr_b16 v[130:131], v14 offset:47456
  ds_read_b64_tr_b16 v[132:133], v14 offset:46208
  ds_read_b64_tr_b16 v[134:135], v14 offset:47488
  s_waitcnt vmcnt(11) lgkmcnt(10)
  v_mfma_f32_16x16x32_bf16 v[136:139], v[96:99], v[48:51], v[136:139]
  v_mfma_f32_16x16x32_bf16 v[140:143], v[100:103], v[48:51], v[140:143]
  v_mfma_f32_16x16x32_bf16 v[144:147], v[104:107], v[48:51], v[144:147]
  v_mfma_f32_16x16x32_bf16 v[148:151], v[108:111], v[48:51], v[148:151]
  v_mfma_f32_16x16x32_bf16 v[152:155], v[112:115], v[48:51], v[152:155]
  ds_read_b64_tr_b16 v[96:97], v15 offset:0
  ds_read_b64_tr_b16 v[98:99], v15 offset:1280
  ds_read_b64_tr_b16 v[100:101], v15 offset:32
  ds_read_b64_tr_b16 v[102:103], v15 offset:1312
  ds_read_b64_tr_b16 v[104:105], v15 offset:64
  ds_read_b64_tr_b16 v[106:107], v15 offset:1344
  ds_read_b64_tr_b16 v[108:109], v15 offset:96
  ds_read_b64_tr_b16 v[110:111], v15 offset:1376
  ds_read_b64_tr_b16 v[112:113], v15 offset:128
  ds_read_b64_tr_b16 v[114:115], v15 offset:1408
  s_waitcnt vmcnt(10) lgkmcnt(10)
  v_mfma_f32_16x16x32_bf16 v[136:139], v[116:119], v[52:55], v[136:139]
  v_mfma_f32_16x16x32_bf16 v[140:143], v[120:123], v[52:55], v[140:143]
  v_mfma_f32_16x16x32_bf16 v[144:147], v[124:127], v[52:55], v[144:147]
  v_mfma_f32_16x16x32_bf16 v[148:151], v[128:131], v[52:55], v[148:151]
  v_mfma_f32_16x16x32_bf16 v[152:155], v[132:135], v[52:55], v[152:155]
  ds_read_b64_tr_b16 v[116:117], v15 offset:5120
  ds_read_b64_tr_b16 v[118:119], v15 offset:6400
  ds_read_b64_tr_b16 v[120:121], v15 offset:5152
  ds_read_b64_tr_b16 v[122:123], v15 offset:6432
  ds_read_b64_tr_b16 v[124:125], v15 offset:5184
  ds_read_b64_tr_b16 v[126:127], v15 offset:6464
  ds_read_b64_tr_b16 v[128:129], v15 offset:5216
  ds_read_b64_tr_b16 v[130:131], v15 offset:6496
  ds_read_b64_tr_b16 v[132:133], v15 offset:5248
  ds_read_b64_tr_b16 v[134:135], v15 offset:6528
  s_waitcnt vmcnt(9) lgkmcnt(10)
  v_mfma_f32_16x16x32_bf16 v[136:139], v[96:99], v[56:59], v[136:139]
  v_mfma_f32_16x16x32_bf16 v[140:143], v[100:103], v[56:59], v[140:143]
  v_mfma_f32_16x16x32_bf16 v[144:147], v[104:107], v[56:59], v[144:147]
  v_mfma_f32_16x16x32_bf16 v[148:151], v[108:111], v[56:59], v[148:151]
  v_mfma_f32_16x16x32_bf16 v[152:155], v[112:115], v[56:59], v[152:155]
  ds_read_b64_tr_b16 v[96:97], v15 offset:10240
  ds_read_b64_tr_b16 v[98:99], v15 offset:11520
  ds_read_b64_tr_b16 v[100:101], v15 offset:10272
  ds_read_b64_tr_b16 v[102:103], v15 offset:11552
  ds_read_b64_tr_b16 v[104:105], v15 offset:10304
  ds_read_b64_tr_b16 v[106:107], v15 offset:11584
  ds_read_b64_tr_b16 v[108:109], v15 offset:10336
  ds_read_b64_tr_b16 v[110:111], v15 offset:11616
  ds_read_b64_tr_b16 v[112:113], v15 offset:10368
  ds_read_b64_tr_b16 v[114:115], v15 offset:11648
  s_waitcnt vmcnt(8) lgkmcnt(10)
  v_mfma_f32_16x16x32_bf16 v[136:139], v[116:119], v[60:63], v[136:139]
  v_mfma_f32_16x16x32_bf16 v[140:143], v[120:123], v[60:63], v[140:143]
  v_mfma_f32_16x16x32_bf16 v[144:147], v[124:127], v[60:63], v[144:147]
  v_mfma_f32_16x16x32_bf16 v[148:151], v[128:131], v[60:63], v[148:151]
  v_mfma_f32_16x16x32_bf16 v[152:155], v[132:135], v[60:63], v[152:155]
  ds_read_b64_tr_b16 v[116:117], v15 offset:15360
  ds_read_b64_tr_b16 v[118:119], v15 offset:16640
  ds_read_b64_tr_b16 v[120:121], v15 offset:15392
  ds_read_b64_tr_b16 v[122:123], v15 offset:16672
  ds_read_b64_tr_b16 v[124:125], v15 offset:15424
  ds_read_b64_tr_b16 v[126:127], v15 offset:16704
  ds_read_b64_tr_b16 v[128:129], v15 offset:15456
  ds_read_b64_tr_b16 v[130:131], v15 offset:16736
  ds_read_b64_tr_b16 v[132:133], v15 offset:15488
  ds_read_b64_tr_b16 v[134:135], v15 offset:16768
  s_waitcnt vmcnt(7) lgkmcnt(10)
  v_mfma_f32_16x16x32_bf16 v[136:139], v[96:99], v[64:67], v[136:139]
  v_mfma_f32_16x16x32_bf16 v[140:143], v[100:103], v[64:67], v[140:143]
  v_mfma_f32_16x16x32_bf16 v[144:147], v[104:107], v[64:67], v[144:147]
  v_mfma_f32_16x16x32_bf16 v[148:151], v[108:111], v[64:67], v[148:151]
  v_mfma_f32_16x16x32_bf16 v[152:155], v[112:115], v[64:67], v[152:155]
  ds_read_b64_tr_b16 v[96:97], v15 offset:20480
  ds_read_b64_tr_b16 v[98:99], v15 offset:21760
  ds_read_b64_tr_b16 v[100:101], v15 offset:20512
  ds_read_b64_tr_b16 v[102:103], v15 offset:21792
  ds_read_b64_tr_b16 v[104:105], v15 offset:20544
  ds_read_b64_tr_b16 v[106:107], v15 offset:21824
  ds_read_b64_tr_b16 v[108:109], v15 offset:20576
  ds_read_b64_tr_b16 v[110:111], v15 offset:21856
  ds_read_b64_tr_b16 v[112:113], v15 offset:20608
  ds_read_b64_tr_b16 v[114:115], v15 offset:21888
  s_waitcnt vmcnt(6) lgkmcnt(10)
  v_mfma_f32_16x16x32_bf16 v[136:139], v[116:119], v[68:71], v[136:139]
  v_mfma_f32_16x16x32_bf16 v[140:143], v[120:123], v[68:71], v[140:143]
  v_mfma_f32_16x16x32_bf16 v[144:147], v[124:127], v[68:71], v[144:147]
  v_mfma_f32_16x16x32_bf16 v[148:151], v[128:131], v[68:71], v[148:151]
  v_mfma_f32_16x16x32_bf16 v[152:155], v[132:135], v[68:71], v[152:155]
  ds_read_b64_tr_b16 v[116:117], v15 offset:25600
  ds_read_b64_tr_b16 v[118:119], v15 offset:26880
  ds_read_b64_tr_b16 v[120:121], v15 offset:25632
  ds_read_b64_tr_b16 v[122:123], v15 offset:26912
  ds_read_b64_tr_b16 v[124:125], v15 offset:25664
  ds_read_b64_tr_b16 v[126:127], v15 offset:26944
  ds_read_b64_tr_b16 v[128:129], v15 offset:25696
  ds_read_b64_tr_b16 v[130:131], v15 offset:26976
  ds_read_b64_tr_b16 v[132:133], v15 offset:25728
  ds_read_b64_tr_b16 v[134:135], v15 offset:27008
  s_waitcnt vmcnt(5) lgkmcnt(10)
  v_mfma_f32_16x16x32_bf16 v[136:139], v[96:99], v[72:75], v[136:139]
  v_mfma_f32_16x16x32_bf16 v[140:143], v[100:103], v[72:75], v[140:143]
  v_mfma_f32_16x16x32_bf16 v[144:147], v[104:107], v[72:75], v[144:147]
  v_mfma_f32_16x16x32_bf16 v[148:151], v[108:111], v[72:75], v[148:151]
  v_mfma_f32_16x16x32_bf16 v[152:155], v[112:115], v[72:75], v[152:155]
  ds_read_b64_tr_b16 v[96:97], v15 offset:30720
  ds_read_b64_tr_b16 v[98:99], v15 offset:32000
  ds_read_b64_tr_b16 v[100:101], v15 offset:30752
  ds_read_b64_tr_b16 v[102:103], v15 offset:32032
  ds_read_b64_tr_b16 v[104:105], v15 offset:30784
  ds_read_b64_tr_b16 v[106:107], v15 offset:32064
  ds_read_b64_tr_b16 v[108:109], v15 offset:30816
  ds_read_b64_tr_b16 v[110:111], v15 offset:32096
  ds_read_b64_tr_b16 v[112:113], v15 offset:30848
  ds_read_b64_tr_b16 v[114:115], v15 offset:32128
  s_waitcnt vmcnt(4) lgkmcnt(10)
  v_mfma_f32_16x16x32_bf16 v[136:139], v[116:119], v[76:79], v[136:139]
  v_mfma_f32_16x16x32_bf16 v[140:143], v[120:123], v[76:79], v[140:143]
  v_mfma_f32_16x16x32_bf16 v[144:147], v[124:127], v[76:79], v[144:147]
  v_mfma_f32_16x16x32_bf16 v[148:151], v[128:131], v[76:79], v[148:151]
  v_mfma_f32_16x16x32_bf16 v[152:155], v[132:135], v[76:79], v[152:155]
  ds_read_b64_tr_b16 v[116:117], v15 offset:35840
  ds_read_b64_tr_b16 v[118:119], v15 offset:37120
  ds_read_b64_tr_b16 v[120:121], v15 offset:35872
  ds_read_b64_tr_b16 v[122:123], v15 offset:37152
  ds_read_b64_tr_b16 v[124:125], v15 offset:35904
  ds_read_b64_tr_b16 v[126:127], v15 offset:37184
  ds_read_b64_tr_b16 v[128:129], v15 offset:35936
  ds_read_b64_tr_b16 v[130:131], v15 offset:37216
  ds_read_b64_tr_b16 v[132:133], v15 offset:35968
  ds_read_b64_tr_b16 v[134:135], v15 offset:37248
  s_waitcnt vmcnt(3) lgkmcnt(10)
  v_mfma_f32_16x16x32_bf16 v[136:139], v[96:99], v[80:83], v[136:139]
  v_mfma_f32_16x16x32_bf16 v[140:143], v[100:103], v[80:83], v[140:143]
  v_mfma_f32_16x16x32_bf16 v[144:147], v[104:107], v[80:83], v[144:147]
  v_mfma_f32_16x16x32_bf16 v[148:151], v[108:111], v[80:83], v[148:151]
  v_mfma_f32_16x16x32_bf16 v[152:155], v[112:115], v[80:83], v[152:155]
  ds_read_b64_tr_b16 v[96:97], v15 offset:40960
  ds_read_b64_tr_b16 v[98:99], v15 offset:42240
  ds_read_b64_tr_b16 v[100:101], v15 offset:40992
  ds_read_b64_tr_b16 v[102:103], v15 offset:42272
  ds_read_b64_tr_b16 v[104:105], v15 offset:41024
  ds_read_b64_tr_b16 v[106:107], v15 offset:42304
  ds_read_b64_tr_b16 v[108:109], v15 offset:41056
  ds_read_b64_tr_b16 v[110:111], v15 offset:42336
  ds_read_b64_tr_b16 v[112:113], v15 offset:41088
  ds_read_b64_tr_b16 v[114:115], v15 offset:42368
  s_waitcnt vmcnt(2) lgkmcnt(10)
  v_mfma_f32_16x16x32_bf16 v[136:139], v[116:119], v[84:87], v[136:139]
  v_mfma_f32_16x16x32_bf16 v[140:143], v[120:123], v[84:87], v[140:143]
  v_mfma_f32_16x16x32_bf16 v[144:147], v[124:127], v[84:87], v[144:147]
  v_mfma_f32_16x16x32_bf16 v[148:151], v[128:131], v[84:87], v[148:151]
  v_mfma_f32_16x16x32_bf16 v[152:155], v[132:135], v[84:87], v[152:155]
  ds_read_b64_tr_b16 v[116:117], v15 offset:46080
  ds_read_b64_tr_b16 v[118:119], v15 offset:47360
  ds_read_b64_tr_b16 v[120:121], v15 offset:46112
  ds_read_b64_tr_b16 v[122:123], v15 offset:47392
  ds_read_b64_tr_b16 v[124:125], v15 offset:46144
  ds_read_b64_tr_b16 v[126:127], v15 offset:47424
  ds_read_b64_tr_b16 v[128:129], v15 offset:46176
  ds_read_b64_tr_b16 v[130:131], v15 offset:47456
  ds_read_b64_tr_b16 v[132:133], v15 offset:46208
  ds_read_b64_tr_b16 v[134:135], v15 offset:47488
  s_waitcnt vmcnt(1) lgkmcnt(10)
  v_mfma_f32_16x16x32_bf16 v[136:139], v[96:99], v[88:91], v[136:139]
  v_mfma_f32_16x16x32_bf16 v[140:143], v[100:103], v[88:91], v[140:143]
  v_mfma_f32_16x16x32_bf16 v[144:147], v[104:107], v[88:91], v[144:147]
  v_mfma_f32_16x16x32_bf16 v[148:151], v[108:111], v[88:91], v[148:151]
  v_mfma_f32_16x16x32_bf16 v[152:155], v[112:115], v[88:91], v[152:155]
  s_waitcnt vmcnt(0) lgkmcnt(0)
  v_mfma_f32_16x16x32_bf16 v[136:139], v[116:119], v[92:95], v[136:139]
  v_mfma_f32_16x16x32_bf16 v[140:143], v[120:123], v[92:95], v[140:143]
  v_mfma_f32_16x16x32_bf16 v[144:147], v[124:127], v[92:95], v[144:147]
  v_mfma_f32_16x16x32_bf16 v[148:151], v[128:131], v[92:95], v[148:151]
  v_mfma_f32_16x16x32_bf16 v[152:155], v[132:135], v[92:95], v[152:155]
  s_nop 9
  v_cvt_pk_bf16_f32 v136, v136, v137
  v_cvt_pk_bf16_f32 v137, v138, v139
  ds_write_b64 v160, v[136:137] offset:0
  v_cvt_pk_bf16_f32 v140, v140, v141
  v_cvt_pk_bf16_f32 v141, v142, v143
  ds_write_b64 v160, v[140:141] offset:32
  v_cvt_pk_bf16_f32 v144, v144, v145
  v_cvt_pk_bf16_f32 v145, v146, v147
  ds_write_b64 v160, v[144:145] offset:64
  v_cvt_pk_bf16_f32 v148, v148, v149
  v_cvt_pk_bf16_f32 v149, v150, v151
  ds_write_b64 v160, v[148:149] offset:96
  v_cvt_pk_bf16_f32 v152, v152, v153
  v_cvt_pk_bf16_f32 v153, v154, v155
  ds_write_b64 v160, v[152:153] offset:128
  s_waitcnt lgkmcnt(0)
  ds_read_b128 v[20:23], v161
  ds_read_b128 v[24:27], v162
  s_mov_b32 exec_lo, -1
  s_mov_b32 exec_hi, 0
  ds_read_b128 v[28:31], v163
  s_mov_b64 exec, -1
  s_waitcnt lgkmcnt(0)
  buffer_store_dwordx4 v[20:23], v164, s[16:19], s35 offen sc1
  buffer_store_dwordx4 v[24:27], v165, s[16:19], s35 offen sc1
  s_mov_b32 exec_lo, -1
  s_mov_b32 exec_hi, 0
  buffer_store_dwordx4 v[28:31], v166, s[16:19], s35 offen sc1
L_tail_kernel_end:
L_tail_kernel_exit:
  s_endpgm
.section .rodata,"a"
.p2align 6
.amdhsa_kernel tail_kernel
  .amdhsa_next_free_vgpr 252
  .amdhsa_next_free_sgpr 100
  .amdhsa_accum_offset 252
  .amdhsa_group_segment_fixed_size 0
  .amdhsa_kernarg_size 72
  .amdhsa_user_sgpr_count 2
  .amdhsa_user_sgpr_kernarg_segment_ptr 1
  .amdhsa_system_sgpr_workgroup_id_x 1
.end_amdhsa_kernel
.text
```
